```python
import torch

def _softmax(x, axis=-1):
    return torch.softmax(x, dim=axis)
def _gelu(x):
    return torch.nn.functional.gelu(x, approximate="tanh")
def _silu(x):
    return torch.nn.functional.silu(x)
def _sigmoid(x):
    return torch.sigmoid(x)
def _layernorm(x, axis=-1, eps=1e-5):
    m = x.mean(dim=axis, keepdim=True)
    v = x.var(dim=axis, keepdim=True, unbiased=False)
    return (x - m) / torch.sqrt(v + eps)
def _scatter_add(tgt, idx, src, axis=0):
    return tgt.clone().index_add_(axis, idx, src)
def _segment_sum(src, seg, n):
    out = torch.zeros((n,) + src.shape[1:], dtype=src.dtype)
    return out.index_add_(0, seg, src)
def _pad(x, pw):
    flat = tuple(v for pair in reversed(pw) for v in pair)
    return torch.nn.functional.pad(x, flat)

kernel_name = 'sequential_preLN__gqa_block_cached__mixer_channel_mlp__decode'

def setup_inputs():

    _w = (lambda a: (lambda t: t.to(torch.bfloat16) if t.is_floating_point() else t)(torch.as_tensor(a)))
    def _A_setup():
        B, Sq, D = 1, 1, 512
        Hq, Hkv, Sk, Dh = 32, 8, 65536, 128
        assert Hq % Hkv == 0, (Hq, Hkv)
        return {
            "x": _w((lambda *s: torch.randn(*s, dtype=torch.bfloat16) * 0.05)(B, Sq, D)),
            "k_cache": _w((lambda *s: torch.randn(*s, dtype=torch.bfloat16) * 3.2)(B, Hkv, Sk, Dh)),
            "v_cache": _w((lambda *s: torch.randn(*s, dtype=torch.bfloat16) * 0.4)(B, Hkv, Sk, Dh)),
            "wq": _w((lambda *s: torch.randn(*s, dtype=torch.bfloat16) * 3.2)(D, Hq * Dh) * (D ** -0.5)),
            "wo": _w((lambda *s: torch.randn(*s, dtype=torch.bfloat16) * 0.4)(Hq * Dh, D) * ((Hq * Dh) ** -0.5)),
        }
    _A_in = _A_setup()

    def _B_setup():
        B, S, D, F = 1, 1, 512, 1792
        return {
            "x": _w((lambda *s: torch.randn(*s, dtype=torch.bfloat16) * 0.05)(B, S, D)),
            "w1": _w((lambda *s: torch.randn(*s, dtype=torch.bfloat16) * 3.2)(D, F) * (D ** -0.5)),
            "b1": _w((lambda *s: torch.randn(*s, dtype=torch.bfloat16) * 3.2)(F)),
            "w2": _w((lambda *s: torch.randn(*s, dtype=torch.bfloat16) * 0.4)(F, D) * (F ** -0.5)),
            "b2": _w((lambda *s: torch.randn(*s, dtype=torch.bfloat16) * 0.8)(D)),
        }
    _B_in = _B_setup()

    return {
        "A_x": _A_in["x"],
        "A_k_cache": _A_in["k_cache"],
        "A_v_cache": _A_in["v_cache"],
        "A_wq": _A_in["wq"],
        "A_wo": _A_in["wo"],
        "B_x": _B_in["x"],
        "B_w1": _B_in["w1"],
        "B_b1": _B_in["b1"],
        "B_w2": _B_in["w2"],
        "B_b2": _B_in["b2"],
    }

def reference(A_x, A_k_cache, A_v_cache, A_wq, A_wo, B_x, B_w1, B_b1, B_w2, B_b2):
    def _A_ref(x, k_cache, v_cache, wq, wo):
        B, Sq, D = x.shape
        Hq, Dh = 32, 128
        Hkv = k_cache.shape[1]
        rep = Hq // Hkv
        q = (lambda x, *d: x.permute(*d))((x @ wq).reshape(B, Sq, Hq, Dh), 0, 2, 1, 3)
        k = (lambda x, n, axis: torch.repeat_interleave(x, n, dim=axis))(k_cache, rep, axis=1)
        v = (lambda x, n, axis: torch.repeat_interleave(x, n, dim=axis))(v_cache, rep, axis=1)
        scores = torch.einsum("bhqd,bhkd->bhqk", q, k) * (Dh ** -0.5)
        p = _softmax(scores, axis=-1)
        o = torch.einsum("bhqk,bhkd->bhqd", p, v)
        return (lambda x, *d: x.permute(*d))(o, 0, 2, 1, 3).reshape(B, Sq, Hq * Dh) @ wo

    def _B_ref(x, w1, b1, w2, b2):
        y = _layernorm(x, axis=-1)
        h = _gelu(torch.einsum("bsd,df->bsf", y, w1) + b1)
        return torch.einsum("bsf,fd->bsd", h, w2) + b2

    x = A_x
    h = x + _A_ref(_layernorm(x, axis=-1), A_k_cache, A_v_cache, A_wq, A_wo)
    h2 = h + _B_ref(_layernorm(h, axis=-1), B_w1, B_b1, B_w2, B_b2)
    return h2
```

```asm
; @launch grid=(256,1,1) block=(512,1,1) lds=20480
.amdgcn_target "amdgcn-amd-amdhsa--gfx950"
.text
.globl sequential_preLN__gqa_block_cached__mixer_channel_mlp__decode_kernel
.p2align 8
.type sequential_preLN__gqa_block_cached__mixer_channel_mlp__decode_kernel,@function
sequential_preLN__gqa_block_cached__mixer_channel_mlp__decode_kernel:
    s_cmp_ge_u32 s2, 256
    s_cbranch_scc1 L_end
    s_load_dwordx2 s[16:17], s[0:1], 0
    s_load_dwordx2 s[20:21], s[0:1], 24
    s_load_dwordx2 s[12:13], s[0:1], 96
    s_load_dwordx2 s[4:5], s[0:1], 8
    s_load_dwordx2 s[8:9], s[0:1], 16
    v_lshrrev_b32 v1, 6, v0
    v_and_b32 v0, 63, v0
    v_mov_b32 v10, 0
    v_mov_b32 v11, 0
    v_readfirstlane_b32 s3, v1
    ds_write_b64 v10, v[10:11] offset:0
    s_lshr_b32 s24, s2, 5
    s_and_b32 s25, s2, 31
    s_mov_b64 s[60:61], -1
    s_mov_b32 s76, 0xff
    s_mov_b32 s77, 0x05040100
    s_mov_b32 s78, 0x07060302
    v_lshlrev_b32 v2, 4, v0
    s_mov_b32 s18, 1024
    s_mov_b32 s19, 0x20000
    s_mov_b32 s22, 4194304
    s_mov_b32 s23, 0x20000
    s_mov_b32 s14, 0x20000000
    s_mov_b32 s15, 0x20000
    s_mov_b32 s6, 0x8000000
    s_mov_b32 s7, 0x20000
    s_mov_b32 s10, 0x8000000
    s_mov_b32 s11, 0x20000
    v_lshrrev_b32 v22, 1, v0
    v_lshlrev_b32 v22, 17, v22
    v_and_b32 v23, 1, v0
    v_lshl_add_u32 v22, v23, 4, v22
    s_and_b32 s93, s25, 7
    s_lshl_b32 s93, s93, 2
    s_lshr_b32 s31, s25, 3
    s_add_u32 s93, s93, s31
    s_lshl_b32 s30, s93, 5
    s_lshl_b32 s31, s24, 10
    s_add_u32 s30, s30, s31
    v_and_b32 v1, 3, v0
    v_lshlrev_b32 v1, 4, v1
    v_bfe_u32 v3, v0, 2, 2
    v_lshl_add_u32 v1, v3, 8, v1
    v_lshrrev_b32 v21, 4, v0
    v_lshl_add_u32 v1, v21, 6, v1
    s_lshl_b32 s26, s24, 24
    s_and_b32 s31, s3, 3
    s_lshl_b32 s31, s31, 13
    s_add_u32 s26, s26, s31
    s_lshl_b32 s31, s25, 17
    s_add_u32 s27, s26, s31
    s_add_u32 s28, s27, 4096
    s_cmp_lg_u32 s3, 0
    s_waitcnt lgkmcnt(0)
    s_cbranch_scc1 L_n0
    s_setprio 3
    buffer_load_dwordx4 v[24:27], v2, s[16:19], 0 offen
    buffer_load_dword v9, v10, s[12:15], 0 offen sc1
    buffer_load_dwordx4 v[64:67], v22, s[20:23], s30 offen
    s_add_u32 s30, s30, 8192
    buffer_load_dwordx4 v[68:71], v22, s[20:23], s30 offen
    s_add_u32 s30, s30, 8192
    buffer_load_dwordx4 v[72:75], v22, s[20:23], s30 offen
    s_add_u32 s30, s30, 8192
    buffer_load_dwordx4 v[76:79], v22, s[20:23], s30 offen
    s_add_u32 s30, s30, 8192
    buffer_load_dwordx4 v[80:83], v22, s[20:23], s30 offen
    s_add_u32 s30, s30, 8192
    buffer_load_dwordx4 v[84:87], v22, s[20:23], s30 offen
    s_add_u32 s30, s30, 8192
    buffer_load_dwordx4 v[88:91], v22, s[20:23], s30 offen
    s_add_u32 s30, s30, 8192
    buffer_load_dwordx4 v[92:95], v22, s[20:23], s30 offen
    s_add_u32 s30, s30, 8192
    buffer_load_dwordx4 v[96:99], v22, s[20:23], s30 offen
    s_add_u32 s30, s30, 8192
    buffer_load_dwordx4 v[100:103], v22, s[20:23], s30 offen
    s_add_u32 s30, s30, 8192
    buffer_load_dwordx4 v[104:107], v22, s[20:23], s30 offen
    s_add_u32 s30, s30, 8192
    buffer_load_dwordx4 v[108:111], v22, s[20:23], s30 offen
    s_add_u32 s30, s30, 8192
    buffer_load_dwordx4 v[112:115], v22, s[20:23], s30 offen
    s_add_u32 s30, s30, 8192
    buffer_load_dwordx4 v[116:119], v22, s[20:23], s30 offen
    s_add_u32 s30, s30, 8192
    buffer_load_dwordx4 v[120:123], v22, s[20:23], s30 offen
    s_add_u32 s30, s30, 8192
    buffer_load_dwordx4 v[124:127], v22, s[20:23], s30 offen
    s_barrier
    s_branch L_h0
L_n0:
    s_cmp_lt_u32 s3, 4
    s_barrier
    s_cbranch_scc1 L_h123
    buffer_load_dwordx4 v[192:195], v1, s[4:7], s27 offen offset:0 nt
    buffer_load_dwordx4 v[196:199], v1, s[4:7], s27 offen offset:1024 nt
    buffer_load_dwordx4 v[200:203], v1, s[4:7], s27 offen offset:2048 nt
    buffer_load_dwordx4 v[204:207], v1, s[4:7], s27 offen offset:3072 nt
    buffer_load_dwordx4 v[208:211], v1, s[4:7], s28 offen offset:0 nt
    buffer_load_dwordx4 v[212:215], v1, s[4:7], s28 offen offset:1024 nt
    buffer_load_dwordx4 v[216:219], v1, s[4:7], s28 offen offset:2048 nt
    buffer_load_dwordx4 v[220:223], v1, s[4:7], s28 offen offset:3072 nt
    buffer_load_dwordx4 v[224:227], v2, s[8:11], s27 offen offset:0 nt
    buffer_load_dwordx4 v[228:231], v2, s[8:11], s27 offen offset:1024 nt
    buffer_load_dwordx4 v[232:235], v2, s[8:11], s27 offen offset:2048 nt
    buffer_load_dwordx4 v[236:239], v2, s[8:11], s27 offen offset:3072 nt
    buffer_load_dwordx4 v[240:243], v2, s[8:11], s28 offen offset:0 nt
    buffer_load_dwordx4 v[244:247], v2, s[8:11], s28 offen offset:1024 nt
    buffer_load_dwordx4 v[248:251], v2, s[8:11], s28 offen offset:2048 nt
    buffer_load_dwordx4 v[252:255], v2, s[8:11], s28 offen offset:3072 nt
    s_and_b32 s3, s3, 3
    v_mov_b32 v3, 0xff7fffff
    v_mov_b32 v8, 0xff7fffff
    v_mov_b32 v4, 0
    v_mov_b32 v5, 0
    v_mov_b32 v6, 0
    s_lshl_b32 s30, s3, 2
    v_mov_b32 v22, s30
    v_add_u32 v7, 48, v22
    s_lshl_b32 s26, s24, 24
    s_sub_u32 s30, s27, s26
    s_add_u32 s30, s30, 0x18000
    v_mov_b32 v9, s30
    v_mov_b32 v32, 0
    v_mov_b32 v33, 0
    v_mov_b32 v34, 0
    v_mov_b32 v35, 0
    v_mov_b32 v36, 0
    v_mov_b32 v37, 0
    v_mov_b32 v38, 0
    v_mov_b32 v39, 0
    v_mov_b32 v40, 0
    v_mov_b32 v41, 0
    v_mov_b32 v42, 0
    v_mov_b32 v43, 0
    v_mov_b32 v44, 0
    v_mov_b32 v45, 0
    v_mov_b32 v46, 0
    v_mov_b32 v47, 0
    v_mov_b32 v48, 0
    v_mov_b32 v49, 0
    v_mov_b32 v50, 0
    v_mov_b32 v51, 0
    v_mov_b32 v52, 0
    v_mov_b32 v53, 0
    v_mov_b32 v54, 0
    v_mov_b32 v55, 0
    v_mov_b32 v56, 0
    v_mov_b32 v57, 0
    v_mov_b32 v58, 0
    v_mov_b32 v59, 0
    v_mov_b32 v60, 0
    v_mov_b32 v61, 0
    v_mov_b32 v62, 0
    v_mov_b32 v63, 0
    s_add_u32 s27, s27, 0x8000
    s_add_u32 s28, s28, 0x8000
    buffer_load_dwordx4 v[128:131], v1, s[4:7], s27 offen offset:0 nt
    buffer_load_dwordx4 v[132:135], v1, s[4:7], s27 offen offset:1024 nt
    buffer_load_dwordx4 v[136:139], v1, s[4:7], s27 offen offset:2048 nt
    buffer_load_dwordx4 v[140:143], v1, s[4:7], s27 offen offset:3072 nt
    buffer_load_dwordx4 v[144:147], v1, s[4:7], s28 offen offset:0 nt
    buffer_load_dwordx4 v[148:151], v1, s[4:7], s28 offen offset:1024 nt
    buffer_load_dwordx4 v[152:155], v1, s[4:7], s28 offen offset:2048 nt
    buffer_load_dwordx4 v[156:159], v1, s[4:7], s28 offen offset:3072 nt
    buffer_load_dwordx4 v[160:163], v2, s[8:11], s27 offen offset:0 nt
    buffer_load_dwordx4 v[164:167], v2, s[8:11], s27 offen offset:1024 nt
    buffer_load_dwordx4 v[168:171], v2, s[8:11], s27 offen offset:2048 nt
    buffer_load_dwordx4 v[172:175], v2, s[8:11], s27 offen offset:3072 nt
    buffer_load_dwordx4 v[176:179], v2, s[8:11], s28 offen offset:0 nt
    buffer_load_dwordx4 v[180:183], v2, s[8:11], s28 offen offset:1024 nt
    buffer_load_dwordx4 v[184:187], v2, s[8:11], s28 offen offset:2048 nt
    buffer_load_dwordx4 v[188:191], v2, s[8:11], s28 offen offset:3072 nt
    s_add_u32 s27, s27, 0x8000
    s_add_u32 s28, s28, 0x8000
    buffer_load_dwordx4 v[64:67], v1, s[4:7], s27 offen offset:0 nt
    buffer_load_dwordx4 v[68:71], v1, s[4:7], s27 offen offset:1024 nt
    buffer_load_dwordx4 v[72:75], v1, s[4:7], s27 offen offset:2048 nt
    buffer_load_dwordx4 v[76:79], v1, s[4:7], s27 offen offset:3072 nt
    buffer_load_dwordx4 v[80:83], v1, s[4:7], s28 offen offset:0 nt
    buffer_load_dwordx4 v[84:87], v1, s[4:7], s28 offen offset:1024 nt
    buffer_load_dwordx4 v[88:91], v1, s[4:7], s28 offen offset:2048 nt
    buffer_load_dwordx4 v[92:95], v1, s[4:7], s28 offen offset:3072 nt
    buffer_load_dwordx4 v[96:99], v2, s[8:11], s27 offen offset:0 nt
    buffer_load_dwordx4 v[100:103], v2, s[8:11], s27 offen offset:1024 nt
    buffer_load_dwordx4 v[104:107], v2, s[8:11], s27 offen offset:2048 nt
    buffer_load_dwordx4 v[108:111], v2, s[8:11], s27 offen offset:3072 nt
    buffer_load_dwordx4 v[112:115], v2, s[8:11], s28 offen offset:0 nt
    buffer_load_dwordx4 v[116:119], v2, s[8:11], s28 offen offset:1024 nt
    buffer_load_dwordx4 v[120:123], v2, s[8:11], s28 offen offset:2048 nt
    buffer_load_dwordx4 v[124:127], v2, s[8:11], s28 offen offset:3072 nt
    s_mov_b32 s63, 2000000
Lq_1:
    ds_read_b32 v20, v10 offset:0
    s_waitcnt lgkmcnt(0)
    v_readfirstlane_b32 s30, v20
    s_cmp_lg_u32 s30, 0
    s_cbranch_scc1 Lqd_2
    s_sleep 1
    s_sub_u32 s63, s63, 1
    s_cmp_lg_u32 s63, 0
    s_cbranch_scc1 Lq_1
Lqd_2:
    ds_read_b128 v[12:15], v2 offset:256
    ds_read_b32 v20, v10 offset:16
L_qok:
L_stream:
    s_mov_b32 s29, 0
    s_mov_b32 s84, 0x88888888
    s_mov_b32 s85, 0x88888888
    s_mov_b32 s80, 0x3db504f3
    s_mov_b32 s82, 0x3fb8aa3b
    s_mov_b32 s63, 2000000
    s_mov_b32 s81, 2
    s_mov_b32 s83, 1
    s_waitcnt lgkmcnt(0)
    v_readfirstlane_b32 s79, v20
    s_waitcnt vmcnt(40)
    v_mfma_f32_16x16x32_bf16 v[24:27], v[192:195], v[12:15], 0
    v_mfma_f32_16x16x32_bf16 v[28:31], v[196:199], v[12:15], 0
    v_mfma_f32_16x16x32_bf16 v[192:195], v[200:203], v[12:15], 0
    v_mfma_f32_16x16x32_bf16 v[196:199], v[204:207], v[12:15], 0
    v_mfma_f32_16x16x32_bf16 v[200:203], v[208:211], v[12:15], 0
    v_mfma_f32_16x16x32_bf16 v[204:207], v[212:215], v[12:15], 0
    v_mfma_f32_16x16x32_bf16 v[208:211], v[216:219], v[12:15], 0
    v_mfma_f32_16x16x32_bf16 v[212:215], v[220:223], v[12:15], 0
    s_nop 0
    v_add_f32_dpp v25, v24, v25 quad_perm:[0,0,0,0] row_mask:0xf bank_mask:0xf
    v_add_f32_dpp v29, v28, v29 quad_perm:[0,0,0,0] row_mask:0xf bank_mask:0xf
    v_add_f32_dpp v193, v192, v193 quad_perm:[0,0,0,0] row_mask:0xf bank_mask:0xf
    v_add_f32_dpp v197, v196, v197 quad_perm:[0,0,0,0] row_mask:0xf bank_mask:0xf
    v_add_f32_dpp v201, v200, v201 quad_perm:[0,0,0,0] row_mask:0xf bank_mask:0xf
    v_add_f32_dpp v205, v204, v205 quad_perm:[0,0,0,0] row_mask:0xf bank_mask:0xf
    v_add_f32_dpp v209, v208, v209 quad_perm:[0,0,0,0] row_mask:0xf bank_mask:0xf
    v_add_f32_dpp v213, v212, v213 quad_perm:[0,0,0,0] row_mask:0xf bank_mask:0xf
    v_add_f32_dpp v27, v26, v27 quad_perm:[2,2,2,2] row_mask:0xf bank_mask:0xf
    v_add_f32_dpp v31, v30, v31 quad_perm:[2,2,2,2] row_mask:0xf bank_mask:0xf
    v_add_f32_dpp v195, v194, v195 quad_perm:[2,2,2,2] row_mask:0xf bank_mask:0xf
    v_add_f32_dpp v199, v198, v199 quad_perm:[2,2,2,2] row_mask:0xf bank_mask:0xf
    v_add_f32_dpp v203, v202, v203 quad_perm:[2,2,2,2] row_mask:0xf bank_mask:0xf
    v_add_f32_dpp v207, v206, v207 quad_perm:[2,2,2,2] row_mask:0xf bank_mask:0xf
    v_add_f32_dpp v211, v210, v211 quad_perm:[2,2,2,2] row_mask:0xf bank_mask:0xf
    v_add_f32_dpp v215, v214, v215 quad_perm:[2,2,2,2] row_mask:0xf bank_mask:0xf
    v_add_f32_dpp v216, v25, v27 quad_perm:[1,1,1,1] row_mask:0xf bank_mask:0xf
    v_add_f32_dpp v217, v29, v31 quad_perm:[1,1,1,1] row_mask:0xf bank_mask:0xf
    v_add_f32_dpp v218, v193, v195 quad_perm:[1,1,1,1] row_mask:0xf bank_mask:0xf
    v_add_f32_dpp v219, v197, v199 quad_perm:[1,1,1,1] row_mask:0xf bank_mask:0xf
    v_add_f32_dpp v220, v201, v203 quad_perm:[1,1,1,1] row_mask:0xf bank_mask:0xf
    v_add_f32_dpp v221, v205, v207 quad_perm:[1,1,1,1] row_mask:0xf bank_mask:0xf
    v_add_f32_dpp v222, v209, v211 quad_perm:[1,1,1,1] row_mask:0xf bank_mask:0xf
    v_add_f32_dpp v223, v213, v215 quad_perm:[1,1,1,1] row_mask:0xf bank_mask:0xf
    v_cvt_pk_bf16_f32 v216, 0, v216
    v_cvt_pk_bf16_f32 v217, 0, v217
    v_cvt_pk_bf16_f32 v218, 0, v218
    v_cvt_pk_bf16_f32 v219, 0, v219
    v_cvt_pk_bf16_f32 v220, 0, v220
    v_cvt_pk_bf16_f32 v221, 0, v221
    v_cvt_pk_bf16_f32 v222, 0, v222
    v_cvt_pk_bf16_f32 v223, 0, v223
    v_mul_f32 v216, s80, v216
    v_mul_f32 v217, s80, v217
    v_mul_f32 v218, s80, v218
    v_mul_f32 v219, s80, v219
    v_mul_f32 v220, s80, v220
    v_mul_f32 v221, s80, v221
    v_mul_f32 v222, s80, v222
    v_mul_f32 v223, s80, v223
    v_cvt_pk_bf16_f32 v216, 0, v216
    v_cvt_pk_bf16_f32 v217, 0, v217
    v_cvt_pk_bf16_f32 v218, 0, v218
    v_cvt_pk_bf16_f32 v219, 0, v219
    v_cvt_pk_bf16_f32 v220, 0, v220
    v_cvt_pk_bf16_f32 v221, 0, v221
    v_cvt_pk_bf16_f32 v222, 0, v222
    v_cvt_pk_bf16_f32 v223, 0, v223
    v_max3_f32 v20, v216, v217, v218
    v_max3_f32 v21, v219, v220, v221
    v_max3_f32 v20, v20, v222, v223
    v_max_f32 v20, v20, v21
    v_cmp_gt_f32 vcc, v20, v8
    s_and_b64 vcc, vcc, s[84:85]
    s_cbranch_execz Lf_3s
    s_cbranch_scc0 Lf_3
Lf_3s:
    v_max_f32 v20, v20, v3
    v_mov_b32 v21, v20
    s_nop 1
    v_permlane32_swap_b32 v20, v21
    v_max_f32 v20, v20, v21
    v_mov_b32 v21, v20
    s_nop 1
    v_permlane16_swap_b32 v20, v21
    v_max_f32 v3, v20, v21
    v_mul_f32 v21, 0xbfb8aa3b, v3
    v_add_f32 v8, 0x41000000, v3
    v_sub_f32 v20, v21, v6
    v_min_f32 v20, 0, v20
    v_exp_f32 v20, v20
    v_mov_b32 v6, v21
    v_mul_f32 v4, v4, v20
    v_mul_f32 v5, v5, v20
    v_mul_f32 v32, v32, v20
    v_mul_f32 v33, v33, v20
    v_mul_f32 v34, v34, v20
    v_mul_f32 v35, v35, v20
    v_mul_f32 v36, v36, v20
    v_mul_f32 v37, v37, v20
    v_mul_f32 v38, v38, v20
    v_mul_f32 v39, v39, v20
    v_mul_f32 v40, v40, v20
    v_mul_f32 v41, v41, v20
    v_mul_f32 v42, v42, v20
    v_mul_f32 v43, v43, v20
    v_mul_f32 v44, v44, v20
    v_mul_f32 v45, v45, v20
    v_mul_f32 v46, v46, v20
    v_mul_f32 v47, v47, v20
    v_mul_f32 v48, v48, v20
    v_mul_f32 v49, v49, v20
    v_mul_f32 v50, v50, v20
    v_mul_f32 v51, v51, v20
    v_mul_f32 v52, v52, v20
    v_mul_f32 v53, v53, v20
    v_mul_f32 v54, v54, v20
    v_mul_f32 v55, v55, v20
    v_mul_f32 v56, v56, v20
    v_mul_f32 v57, v57, v20
    v_mul_f32 v58, v58, v20
    v_mul_f32 v59, v59, v20
    v_mul_f32 v60, v60, v20
    v_mul_f32 v61, v61, v20
    v_mul_f32 v62, v62, v20
    v_mul_f32 v63, v63, v20
Lf_3:
    v_fma_f32 v216, v216, s82, v6
    v_fma_f32 v217, v217, s82, v6
    v_fma_f32 v218, v218, s82, v6
    v_fma_f32 v219, v219, s82, v6
    v_fma_f32 v220, v220, s82, v6
    v_fma_f32 v221, v221, s82, v6
    v_fma_f32 v222, v222, s82, v6
    v_fma_f32 v223, v223, s82, v6
    v_exp_f32 v216, v216
    v_exp_f32 v217, v217
    v_exp_f32 v218, v218
    v_exp_f32 v219, v219
    v_exp_f32 v220, v220
    v_exp_f32 v221, v221
    v_exp_f32 v222, v222
    v_exp_f32 v223, v223
    v_cvt_pk_bf16_f32 v16, v216, v217
    v_cvt_pk_bf16_f32 v17, v218, v219
    v_cvt_pk_bf16_f32 v18, v220, v221
    v_cvt_pk_bf16_f32 v19, v222, v223
    v_add_f32 v4, v4, v216
    v_add_f32 v5, v5, v217
    v_add_f32 v4, v4, v218
    v_add_f32 v5, v5, v219
    v_add_f32 v4, v4, v220
    v_add_f32 v5, v5, v221
    v_add_f32 v4, v4, v222
    v_add_f32 v5, v5, v223
    s_waitcnt vmcnt(32)
    v_perm_b32 v192, v228, v224, s77
    v_perm_b32 v193, v236, v232, s77
    v_perm_b32 v194, v244, v240, s77
    v_perm_b32 v195, v252, v248, s77
    v_perm_b32 v196, v228, v224, s78
    v_perm_b32 v197, v236, v232, s78
    v_perm_b32 v198, v244, v240, s78
    v_perm_b32 v199, v252, v248, s78
    v_perm_b32 v200, v229, v225, s77
    v_perm_b32 v201, v237, v233, s77
    v_perm_b32 v202, v245, v241, s77
    v_perm_b32 v203, v253, v249, s77
    v_perm_b32 v204, v229, v225, s78
    v_perm_b32 v205, v237, v233, s78
    v_perm_b32 v206, v245, v241, s78
    v_perm_b32 v207, v253, v249, s78
    v_mfma_f32_16x16x32_bf16 v[32:35], v[192:195], v[16:19], v[32:35]
    v_mfma_f32_16x16x32_bf16 v[36:39], v[196:199], v[16:19], v[36:39]
    v_perm_b32 v208, v230, v226, s77
    v_perm_b32 v209, v238, v234, s77
    v_perm_b32 v210, v246, v242, s77
    v_perm_b32 v211, v254, v250, s77
    v_perm_b32 v212, v230, v226, s78
    v_perm_b32 v213, v238, v234, s78
    v_perm_b32 v214, v246, v242, s78
    v_perm_b32 v215, v254, v250, s78
    v_mfma_f32_16x16x32_bf16 v[40:43], v[200:203], v[16:19], v[40:43]
    v_mfma_f32_16x16x32_bf16 v[44:47], v[204:207], v[16:19], v[44:47]
    v_perm_b32 v216, v231, v227, s77
    v_perm_b32 v217, v239, v235, s77
    v_perm_b32 v218, v247, v243, s77
    v_perm_b32 v219, v255, v251, s77
    v_perm_b32 v220, v231, v227, s78
    v_perm_b32 v221, v239, v235, s78
    v_perm_b32 v222, v247, v243, s78
    v_perm_b32 v223, v255, v251, s78
    v_mfma_f32_16x16x32_bf16 v[48:51], v[208:211], v[16:19], v[48:51]
    v_mfma_f32_16x16x32_bf16 v[52:55], v[212:215], v[16:19], v[52:55]
    v_mfma_f32_16x16x32_bf16 v[56:59], v[216:219], v[16:19], v[56:59]
    v_mfma_f32_16x16x32_bf16 v[60:63], v[220:223], v[16:19], v[60:63]
    s_waitcnt vmcnt(24)
    v_mfma_f32_16x16x32_bf16 v[24:27], v[128:131], v[12:15], 0
    v_mfma_f32_16x16x32_bf16 v[28:31], v[132:135], v[12:15], 0
    v_mfma_f32_16x16x32_bf16 v[128:131], v[136:139], v[12:15], 0
    v_mfma_f32_16x16x32_bf16 v[132:135], v[140:143], v[12:15], 0
    v_mfma_f32_16x16x32_bf16 v[136:139], v[144:147], v[12:15], 0
    v_mfma_f32_16x16x32_bf16 v[140:143], v[148:151], v[12:15], 0
    v_mfma_f32_16x16x32_bf16 v[144:147], v[152:155], v[12:15], 0
    v_mfma_f32_16x16x32_bf16 v[148:151], v[156:159], v[12:15], 0
    s_nop 0
    v_add_f32_dpp v25, v24, v25 quad_perm:[0,0,0,0] row_mask:0xf bank_mask:0xf
    v_add_f32_dpp v29, v28, v29 quad_perm:[0,0,0,0] row_mask:0xf bank_mask:0xf
    v_add_f32_dpp v129, v128, v129 quad_perm:[0,0,0,0] row_mask:0xf bank_mask:0xf
    v_add_f32_dpp v133, v132, v133 quad_perm:[0,0,0,0] row_mask:0xf bank_mask:0xf
    v_add_f32_dpp v137, v136, v137 quad_perm:[0,0,0,0] row_mask:0xf bank_mask:0xf
    v_add_f32_dpp v141, v140, v141 quad_perm:[0,0,0,0] row_mask:0xf bank_mask:0xf
    v_add_f32_dpp v145, v144, v145 quad_perm:[0,0,0,0] row_mask:0xf bank_mask:0xf
    v_add_f32_dpp v149, v148, v149 quad_perm:[0,0,0,0] row_mask:0xf bank_mask:0xf
    v_add_f32_dpp v27, v26, v27 quad_perm:[2,2,2,2] row_mask:0xf bank_mask:0xf
    v_add_f32_dpp v31, v30, v31 quad_perm:[2,2,2,2] row_mask:0xf bank_mask:0xf
    v_add_f32_dpp v131, v130, v131 quad_perm:[2,2,2,2] row_mask:0xf bank_mask:0xf
    v_add_f32_dpp v135, v134, v135 quad_perm:[2,2,2,2] row_mask:0xf bank_mask:0xf
    v_add_f32_dpp v139, v138, v139 quad_perm:[2,2,2,2] row_mask:0xf bank_mask:0xf
    v_add_f32_dpp v143, v142, v143 quad_perm:[2,2,2,2] row_mask:0xf bank_mask:0xf
    v_add_f32_dpp v147, v146, v147 quad_perm:[2,2,2,2] row_mask:0xf bank_mask:0xf
    v_add_f32_dpp v151, v150, v151 quad_perm:[2,2,2,2] row_mask:0xf bank_mask:0xf
    v_add_f32_dpp v152, v25, v27 quad_perm:[1,1,1,1] row_mask:0xf bank_mask:0xf
    v_add_f32_dpp v153, v29, v31 quad_perm:[1,1,1,1] row_mask:0xf bank_mask:0xf
    v_add_f32_dpp v154, v129, v131 quad_perm:[1,1,1,1] row_mask:0xf bank_mask:0xf
    v_add_f32_dpp v155, v133, v135 quad_perm:[1,1,1,1] row_mask:0xf bank_mask:0xf
    v_add_f32_dpp v156, v137, v139 quad_perm:[1,1,1,1] row_mask:0xf bank_mask:0xf
    v_add_f32_dpp v157, v141, v143 quad_perm:[1,1,1,1] row_mask:0xf bank_mask:0xf
    v_add_f32_dpp v158, v145, v147 quad_perm:[1,1,1,1] row_mask:0xf bank_mask:0xf
    v_add_f32_dpp v159, v149, v151 quad_perm:[1,1,1,1] row_mask:0xf bank_mask:0xf
    v_cvt_pk_bf16_f32 v152, 0, v152
    v_cvt_pk_bf16_f32 v153, 0, v153
    v_cvt_pk_bf16_f32 v154, 0, v154
    v_cvt_pk_bf16_f32 v155, 0, v155
    v_cvt_pk_bf16_f32 v156, 0, v156
    v_cvt_pk_bf16_f32 v157, 0, v157
    v_cvt_pk_bf16_f32 v158, 0, v158
    v_cvt_pk_bf16_f32 v159, 0, v159
    v_mul_f32 v152, s80, v152
    v_mul_f32 v153, s80, v153
    v_mul_f32 v154, s80, v154
    v_mul_f32 v155, s80, v155
    v_mul_f32 v156, s80, v156
    v_mul_f32 v157, s80, v157
    v_mul_f32 v158, s80, v158
    v_mul_f32 v159, s80, v159
    v_cvt_pk_bf16_f32 v152, 0, v152
    v_cvt_pk_bf16_f32 v153, 0, v153
    v_cvt_pk_bf16_f32 v154, 0, v154
    v_cvt_pk_bf16_f32 v155, 0, v155
    v_cvt_pk_bf16_f32 v156, 0, v156
    v_cvt_pk_bf16_f32 v157, 0, v157
    v_cvt_pk_bf16_f32 v158, 0, v158
    v_cvt_pk_bf16_f32 v159, 0, v159
    v_max3_f32 v20, v152, v153, v154
    v_max3_f32 v21, v155, v156, v157
    v_max3_f32 v20, v20, v158, v159
    v_max_f32 v20, v20, v21
    v_cmp_gt_f32 vcc, v20, v8
    s_and_b64 vcc, vcc, s[84:85]
    s_cbranch_execz Lf_4s
    s_cbranch_scc0 Lf_4
Lf_4s:
    v_max_f32 v20, v20, v3
    v_mov_b32 v21, v20
    s_nop 1
    v_permlane32_swap_b32 v20, v21
    v_max_f32 v20, v20, v21
    v_mov_b32 v21, v20
    s_nop 1
    v_permlane16_swap_b32 v20, v21
    v_max_f32 v3, v20, v21
    v_mul_f32 v21, 0xbfb8aa3b, v3
    v_add_f32 v8, 0x41000000, v3
    v_sub_f32 v20, v21, v6
    v_min_f32 v20, 0, v20
    v_exp_f32 v20, v20
    v_mov_b32 v6, v21
    v_mul_f32 v4, v4, v20
    v_mul_f32 v5, v5, v20
    v_mul_f32 v32, v32, v20
    v_mul_f32 v33, v33, v20
    v_mul_f32 v34, v34, v20
    v_mul_f32 v35, v35, v20
    v_mul_f32 v36, v36, v20
    v_mul_f32 v37, v37, v20
    v_mul_f32 v38, v38, v20
    v_mul_f32 v39, v39, v20
    v_mul_f32 v40, v40, v20
    v_mul_f32 v41, v41, v20
    v_mul_f32 v42, v42, v20
    v_mul_f32 v43, v43, v20
    v_mul_f32 v44, v44, v20
    v_mul_f32 v45, v45, v20
    v_mul_f32 v46, v46, v20
    v_mul_f32 v47, v47, v20
    v_mul_f32 v48, v48, v20
    v_mul_f32 v49, v49, v20
    v_mul_f32 v50, v50, v20
    v_mul_f32 v51, v51, v20
    v_mul_f32 v52, v52, v20
    v_mul_f32 v53, v53, v20
    v_mul_f32 v54, v54, v20
    v_mul_f32 v55, v55, v20
    v_mul_f32 v56, v56, v20
    v_mul_f32 v57, v57, v20
    v_mul_f32 v58, v58, v20
    v_mul_f32 v59, v59, v20
    v_mul_f32 v60, v60, v20
    v_mul_f32 v61, v61, v20
    v_mul_f32 v62, v62, v20
    v_mul_f32 v63, v63, v20
Lf_4:
    v_fma_f32 v152, v152, s82, v6
    v_fma_f32 v153, v153, s82, v6
    v_fma_f32 v154, v154, s82, v6
    v_fma_f32 v155, v155, s82, v6
    v_fma_f32 v156, v156, s82, v6
    v_fma_f32 v157, v157, s82, v6
    v_fma_f32 v158, v158, s82, v6
    v_fma_f32 v159, v159, s82, v6
    v_exp_f32 v152, v152
    v_exp_f32 v153, v153
    v_exp_f32 v154, v154
    v_exp_f32 v155, v155
    v_exp_f32 v156, v156
    v_exp_f32 v157, v157
    v_exp_f32 v158, v158
    v_exp_f32 v159, v159
    v_cvt_pk_bf16_f32 v16, v152, v153
    v_cvt_pk_bf16_f32 v17, v154, v155
    v_cvt_pk_bf16_f32 v18, v156, v157
    v_cvt_pk_bf16_f32 v19, v158, v159
    v_add_f32 v4, v4, v152
    v_add_f32 v5, v5, v153
    v_add_f32 v4, v4, v154
    v_add_f32 v5, v5, v155
    v_add_f32 v4, v4, v156
    v_add_f32 v5, v5, v157
    v_add_f32 v4, v4, v158
    v_add_f32 v5, v5, v159
    s_waitcnt vmcnt(16)
    v_perm_b32 v128, v164, v160, s77
    v_perm_b32 v129, v172, v168, s77
    v_perm_b32 v130, v180, v176, s77
    v_perm_b32 v131, v188, v184, s77
    v_perm_b32 v132, v164, v160, s78
    v_perm_b32 v133, v172, v168, s78
    v_perm_b32 v134, v180, v176, s78
    v_perm_b32 v135, v188, v184, s78
    v_perm_b32 v136, v165, v161, s77
    v_perm_b32 v137, v173, v169, s77
    v_perm_b32 v138, v181, v177, s77
    v_perm_b32 v139, v189, v185, s77
    v_perm_b32 v140, v165, v161, s78
    v_perm_b32 v141, v173, v169, s78
    v_perm_b32 v142, v181, v177, s78
    v_perm_b32 v143, v189, v185, s78
    v_mfma_f32_16x16x32_bf16 v[32:35], v[128:131], v[16:19], v[32:35]
    v_mfma_f32_16x16x32_bf16 v[36:39], v[132:135], v[16:19], v[36:39]
    v_perm_b32 v144, v166, v162, s77
    v_perm_b32 v145, v174, v170, s77
    v_perm_b32 v146, v182, v178, s77
    v_perm_b32 v147, v190, v186, s77
    v_perm_b32 v148, v166, v162, s78
    v_perm_b32 v149, v174, v170, s78
    v_perm_b32 v150, v182, v178, s78
    v_perm_b32 v151, v190, v186, s78
    v_mfma_f32_16x16x32_bf16 v[40:43], v[136:139], v[16:19], v[40:43]
    v_mfma_f32_16x16x32_bf16 v[44:47], v[140:143], v[16:19], v[44:47]
    v_perm_b32 v152, v167, v163, s77
    v_perm_b32 v153, v175, v171, s77
    v_perm_b32 v154, v183, v179, s77
    v_perm_b32 v155, v191, v187, s77
    v_perm_b32 v156, v167, v163, s78
    v_perm_b32 v157, v175, v171, s78
    v_perm_b32 v158, v183, v179, s78
    v_perm_b32 v159, v191, v187, s78
    v_mfma_f32_16x16x32_bf16 v[48:51], v[144:147], v[16:19], v[48:51]
    v_mfma_f32_16x16x32_bf16 v[52:55], v[148:151], v[16:19], v[52:55]
    v_mfma_f32_16x16x32_bf16 v[56:59], v[152:155], v[16:19], v[56:59]
    v_mfma_f32_16x16x32_bf16 v[60:63], v[156:159], v[16:19], v[60:63]
    s_cbranch_execz L_sdone
.p2align 3
L_loop:
    s_waitcnt vmcnt(8) lgkmcnt(0)
Lk_5r:
    v_readfirstlane_b32 s30, v9
    s_cmp_lt_i32 s30, 0
    s_cbranch_scc1 Lk_5x
    s_cbranch_execz Lk_5
    s_add_u32 s27, s26, s30
    s_add_u32 s28, s27, 4096
    v_add_u32 v7, 16, v7
    ds_write_b32 v22, v7 offset:32
    buffer_load_dwordx4 v[128:131], v1, s[4:7], s27 offen offset:0 nt
    buffer_load_dwordx4 v[132:135], v1, s[4:7], s27 offen offset:1024 nt
    buffer_load_dwordx4 v[136:139], v1, s[4:7], s27 offen offset:2048 nt
    buffer_load_dwordx4 v[140:143], v1, s[4:7], s27 offen offset:3072 nt
    buffer_load_dwordx4 v[144:147], v1, s[4:7], s28 offen offset:0 nt
    buffer_load_dwordx4 v[148:151], v1, s[4:7], s28 offen offset:1024 nt
    buffer_load_dwordx4 v[152:155], v1, s[4:7], s28 offen offset:2048 nt
    buffer_load_dwordx4 v[156:159], v1, s[4:7], s28 offen offset:3072 nt
Lk_5:
    v_mfma_f32_16x16x32_bf16 v[24:27], v[64:67], v[12:15], 0
    v_mfma_f32_16x16x32_bf16 v[28:31], v[68:71], v[12:15], 0
    v_mfma_f32_16x16x32_bf16 v[64:67], v[72:75], v[12:15], 0
    v_mfma_f32_16x16x32_bf16 v[68:71], v[76:79], v[12:15], 0
    v_mfma_f32_16x16x32_bf16 v[72:75], v[80:83], v[12:15], 0
    v_mfma_f32_16x16x32_bf16 v[76:79], v[84:87], v[12:15], 0
    v_mfma_f32_16x16x32_bf16 v[80:83], v[88:91], v[12:15], 0
    v_mfma_f32_16x16x32_bf16 v[84:87], v[92:95], v[12:15], 0
    s_nop 0
    v_add_f32_dpp v25, v24, v25 quad_perm:[0,0,0,0] row_mask:0xf bank_mask:0xf
    v_add_f32_dpp v29, v28, v29 quad_perm:[0,0,0,0] row_mask:0xf bank_mask:0xf
    v_add_f32_dpp v65, v64, v65 quad_perm:[0,0,0,0] row_mask:0xf bank_mask:0xf
    v_add_f32_dpp v69, v68, v69 quad_perm:[0,0,0,0] row_mask:0xf bank_mask:0xf
    v_add_f32_dpp v73, v72, v73 quad_perm:[0,0,0,0] row_mask:0xf bank_mask:0xf
    v_add_f32_dpp v77, v76, v77 quad_perm:[0,0,0,0] row_mask:0xf bank_mask:0xf
    v_add_f32_dpp v81, v80, v81 quad_perm:[0,0,0,0] row_mask:0xf bank_mask:0xf
    v_add_f32_dpp v85, v84, v85 quad_perm:[0,0,0,0] row_mask:0xf bank_mask:0xf
    v_add_f32_dpp v27, v26, v27 quad_perm:[2,2,2,2] row_mask:0xf bank_mask:0xf
    v_add_f32_dpp v31, v30, v31 quad_perm:[2,2,2,2] row_mask:0xf bank_mask:0xf
    v_add_f32_dpp v67, v66, v67 quad_perm:[2,2,2,2] row_mask:0xf bank_mask:0xf
    v_add_f32_dpp v71, v70, v71 quad_perm:[2,2,2,2] row_mask:0xf bank_mask:0xf
    v_add_f32_dpp v75, v74, v75 quad_perm:[2,2,2,2] row_mask:0xf bank_mask:0xf
    v_add_f32_dpp v79, v78, v79 quad_perm:[2,2,2,2] row_mask:0xf bank_mask:0xf
    v_add_f32_dpp v83, v82, v83 quad_perm:[2,2,2,2] row_mask:0xf bank_mask:0xf
    v_add_f32_dpp v87, v86, v87 quad_perm:[2,2,2,2] row_mask:0xf bank_mask:0xf
    v_add_f32_dpp v88, v25, v27 quad_perm:[1,1,1,1] row_mask:0xf bank_mask:0xf
    v_add_f32_dpp v89, v29, v31 quad_perm:[1,1,1,1] row_mask:0xf bank_mask:0xf
    v_add_f32_dpp v90, v65, v67 quad_perm:[1,1,1,1] row_mask:0xf bank_mask:0xf
    v_add_f32_dpp v91, v69, v71 quad_perm:[1,1,1,1] row_mask:0xf bank_mask:0xf
    v_add_f32_dpp v92, v73, v75 quad_perm:[1,1,1,1] row_mask:0xf bank_mask:0xf
    v_add_f32_dpp v93, v77, v79 quad_perm:[1,1,1,1] row_mask:0xf bank_mask:0xf
    v_add_f32_dpp v94, v81, v83 quad_perm:[1,1,1,1] row_mask:0xf bank_mask:0xf
    v_add_f32_dpp v95, v85, v87 quad_perm:[1,1,1,1] row_mask:0xf bank_mask:0xf
    v_cvt_pk_bf16_f32 v88, 0, v88
    v_cvt_pk_bf16_f32 v89, 0, v89
    v_cvt_pk_bf16_f32 v90, 0, v90
    v_cvt_pk_bf16_f32 v91, 0, v91
    v_cvt_pk_bf16_f32 v92, 0, v92
    v_cvt_pk_bf16_f32 v93, 0, v93
    v_cvt_pk_bf16_f32 v94, 0, v94
    v_cvt_pk_bf16_f32 v95, 0, v95
    v_mul_f32 v88, s80, v88
    v_mul_f32 v89, s80, v89
    v_mul_f32 v90, s80, v90
    v_mul_f32 v91, s80, v91
    v_mul_f32 v92, s80, v92
    v_mul_f32 v93, s80, v93
    v_mul_f32 v94, s80, v94
    v_mul_f32 v95, s80, v95
    v_cvt_pk_bf16_f32 v88, 0, v88
    v_cvt_pk_bf16_f32 v89, 0, v89
    v_cvt_pk_bf16_f32 v90, 0, v90
    v_cvt_pk_bf16_f32 v91, 0, v91
    v_cvt_pk_bf16_f32 v92, 0, v92
    v_cvt_pk_bf16_f32 v93, 0, v93
    v_cvt_pk_bf16_f32 v94, 0, v94
    v_cvt_pk_bf16_f32 v95, 0, v95
    v_max3_f32 v20, v88, v89, v90
    v_max3_f32 v21, v91, v92, v93
    v_max3_f32 v20, v20, v94, v95
    v_max_f32 v20, v20, v21
    v_cmp_gt_f32 vcc, v20, v8
    s_and_b64 vcc, vcc, s[84:85]
    s_cbranch_execz Lf_6s
    s_cbranch_scc0 Lf_6
Lf_6s:
    v_max_f32 v20, v20, v3
    v_mov_b32 v21, v20
    s_nop 1
    v_permlane32_swap_b32 v20, v21
    v_max_f32 v20, v20, v21
    v_mov_b32 v21, v20
    s_nop 1
    v_permlane16_swap_b32 v20, v21
    v_max_f32 v3, v20, v21
    v_mul_f32 v21, 0xbfb8aa3b, v3
    v_add_f32 v8, 0x41000000, v3
    v_sub_f32 v20, v21, v6
    v_min_f32 v20, 0, v20
    v_exp_f32 v20, v20
    v_mov_b32 v6, v21
    v_mul_f32 v4, v4, v20
    v_mul_f32 v5, v5, v20
    v_mul_f32 v32, v32, v20
    v_mul_f32 v33, v33, v20
    v_mul_f32 v34, v34, v20
    v_mul_f32 v35, v35, v20
    v_mul_f32 v36, v36, v20
    v_mul_f32 v37, v37, v20
    v_mul_f32 v38, v38, v20
    v_mul_f32 v39, v39, v20
    v_mul_f32 v40, v40, v20
    v_mul_f32 v41, v41, v20
    v_mul_f32 v42, v42, v20
    v_mul_f32 v43, v43, v20
    v_mul_f32 v44, v44, v20
    v_mul_f32 v45, v45, v20
    v_mul_f32 v46, v46, v20
    v_mul_f32 v47, v47, v20
    v_mul_f32 v48, v48, v20
    v_mul_f32 v49, v49, v20
    v_mul_f32 v50, v50, v20
    v_mul_f32 v51, v51, v20
    v_mul_f32 v52, v52, v20
    v_mul_f32 v53, v53, v20
    v_mul_f32 v54, v54, v20
    v_mul_f32 v55, v55, v20
    v_mul_f32 v56, v56, v20
    v_mul_f32 v57, v57, v20
    v_mul_f32 v58, v58, v20
    v_mul_f32 v59, v59, v20
    v_mul_f32 v60, v60, v20
    v_mul_f32 v61, v61, v20
    v_mul_f32 v62, v62, v20
    v_mul_f32 v63, v63, v20
Lf_6:
    v_fma_f32 v88, v88, s82, v6
    v_fma_f32 v89, v89, s82, v6
    v_fma_f32 v90, v90, s82, v6
    v_fma_f32 v91, v91, s82, v6
    v_fma_f32 v92, v92, s82, v6
    v_fma_f32 v93, v93, s82, v6
    v_fma_f32 v94, v94, s82, v6
    v_fma_f32 v95, v95, s82, v6
    v_exp_f32 v88, v88
    v_exp_f32 v89, v89
    v_exp_f32 v90, v90
    v_exp_f32 v91, v91
    v_exp_f32 v92, v92
    v_exp_f32 v93, v93
    v_exp_f32 v94, v94
    v_exp_f32 v95, v95
    v_cvt_pk_bf16_f32 v16, v88, v89
    v_cvt_pk_bf16_f32 v17, v90, v91
    v_cvt_pk_bf16_f32 v18, v92, v93
    v_cvt_pk_bf16_f32 v19, v94, v95
    v_add_f32 v4, v4, v88
    v_add_f32 v5, v5, v89
    v_add_f32 v4, v4, v90
    v_add_f32 v5, v5, v91
    v_add_f32 v4, v4, v92
    v_add_f32 v5, v5, v93
    v_add_f32 v4, v4, v94
    v_add_f32 v5, v5, v95
    s_waitcnt vmcnt(8)
    s_cmp_lg_u32 s29, 0
    s_cbranch_scc1 Lw_7e
    s_cbranch_execz Lw_7
    buffer_load_dwordx4 v[160:163], v2, s[8:11], s27 offen offset:0 nt
    buffer_load_dwordx4 v[164:167], v2, s[8:11], s27 offen offset:1024 nt
    buffer_load_dwordx4 v[168:171], v2, s[8:11], s27 offen offset:2048 nt
    buffer_load_dwordx4 v[172:175], v2, s[8:11], s27 offen offset:3072 nt
    buffer_load_dwordx4 v[176:179], v2, s[8:11], s28 offen offset:0 nt
    buffer_load_dwordx4 v[180:183], v2, s[8:11], s28 offen offset:1024 nt
    buffer_load_dwordx4 v[184:187], v2, s[8:11], s28 offen offset:2048 nt
    buffer_load_dwordx4 v[188:191], v2, s[8:11], s28 offen offset:3072 nt
Lw_7:
Lw_7f:
    v_perm_b32 v64, v100, v96, s77
    v_perm_b32 v65, v108, v104, s77
    v_perm_b32 v66, v116, v112, s77
    v_perm_b32 v67, v124, v120, s77
    v_perm_b32 v68, v100, v96, s78
    v_perm_b32 v69, v108, v104, s78
    v_perm_b32 v70, v116, v112, s78
    v_perm_b32 v71, v124, v120, s78
    v_perm_b32 v72, v101, v97, s77
    v_perm_b32 v73, v109, v105, s77
    v_perm_b32 v74, v117, v113, s77
    v_perm_b32 v75, v125, v121, s77
    v_perm_b32 v76, v101, v97, s78
    v_perm_b32 v77, v109, v105, s78
    v_perm_b32 v78, v117, v113, s78
    v_perm_b32 v79, v125, v121, s78
    v_mfma_f32_16x16x32_bf16 v[32:35], v[64:67], v[16:19], v[32:35]
    v_mfma_f32_16x16x32_bf16 v[36:39], v[68:71], v[16:19], v[36:39]
    v_perm_b32 v80, v102, v98, s77
    v_perm_b32 v81, v110, v106, s77
    v_perm_b32 v82, v118, v114, s77
    v_perm_b32 v83, v126, v122, s77
    v_perm_b32 v84, v102, v98, s78
    v_perm_b32 v85, v110, v106, s78
    v_perm_b32 v86, v118, v114, s78
    v_perm_b32 v87, v126, v122, s78
    v_mfma_f32_16x16x32_bf16 v[40:43], v[72:75], v[16:19], v[40:43]
    v_mfma_f32_16x16x32_bf16 v[44:47], v[76:79], v[16:19], v[44:47]
    v_perm_b32 v88, v103, v99, s77
    v_perm_b32 v89, v111, v107, s77
    v_perm_b32 v90, v119, v115, s77
    v_perm_b32 v91, v127, v123, s77
    v_perm_b32 v92, v103, v99, s78
    v_perm_b32 v93, v111, v107, s78
    v_perm_b32 v94, v119, v115, s78
    v_perm_b32 v95, v127, v123, s78
    v_mfma_f32_16x16x32_bf16 v[48:51], v[80:83], v[16:19], v[48:51]
    v_mfma_f32_16x16x32_bf16 v[52:55], v[84:87], v[16:19], v[52:55]
    ds_read_b32 v9, v7 offset:1536
    v_mfma_f32_16x16x32_bf16 v[56:59], v[88:91], v[16:19], v[56:59]
    v_mfma_f32_16x16x32_bf16 v[60:63], v[92:95], v[16:19], v[60:63]
    s_cmp_lg_u32 s29, 0
    s_cbranch_scc1 L_sdone
L_loop2:
    s_waitcnt vmcnt(8) lgkmcnt(0)
Lk_8r:
    v_readfirstlane_b32 s30, v9
    s_cmp_lt_i32 s30, 0
    s_cbranch_scc1 Lk_8x
    s_cbranch_execz Lk_8
    s_add_u32 s27, s26, s30
    s_add_u32 s28, s27, 4096
    v_add_u32 v7, 16, v7
    ds_write_b32 v22, v7 offset:32
    buffer_load_dwordx4 v[64:67], v1, s[4:7], s27 offen offset:0 nt
    buffer_load_dwordx4 v[68:71], v1, s[4:7], s27 offen offset:1024 nt
    buffer_load_dwordx4 v[72:75], v1, s[4:7], s27 offen offset:2048 nt
    buffer_load_dwordx4 v[76:79], v1, s[4:7], s27 offen offset:3072 nt
    buffer_load_dwordx4 v[80:83], v1, s[4:7], s28 offen offset:0 nt
    buffer_load_dwordx4 v[84:87], v1, s[4:7], s28 offen offset:1024 nt
    buffer_load_dwordx4 v[88:91], v1, s[4:7], s28 offen offset:2048 nt
    buffer_load_dwordx4 v[92:95], v1, s[4:7], s28 offen offset:3072 nt
Lk_8:
    v_mfma_f32_16x16x32_bf16 v[24:27], v[128:131], v[12:15], 0
    v_mfma_f32_16x16x32_bf16 v[28:31], v[132:135], v[12:15], 0
    v_mfma_f32_16x16x32_bf16 v[128:131], v[136:139], v[12:15], 0
    v_mfma_f32_16x16x32_bf16 v[132:135], v[140:143], v[12:15], 0
    v_mfma_f32_16x16x32_bf16 v[136:139], v[144:147], v[12:15], 0
    v_mfma_f32_16x16x32_bf16 v[140:143], v[148:151], v[12:15], 0
    v_mfma_f32_16x16x32_bf16 v[144:147], v[152:155], v[12:15], 0
    v_mfma_f32_16x16x32_bf16 v[148:151], v[156:159], v[12:15], 0
    s_nop 0
    v_add_f32_dpp v25, v24, v25 quad_perm:[0,0,0,0] row_mask:0xf bank_mask:0xf
    v_add_f32_dpp v29, v28, v29 quad_perm:[0,0,0,0] row_mask:0xf bank_mask:0xf
    v_add_f32_dpp v129, v128, v129 quad_perm:[0,0,0,0] row_mask:0xf bank_mask:0xf
    v_add_f32_dpp v133, v132, v133 quad_perm:[0,0,0,0] row_mask:0xf bank_mask:0xf
    v_add_f32_dpp v137, v136, v137 quad_perm:[0,0,0,0] row_mask:0xf bank_mask:0xf
    v_add_f32_dpp v141, v140, v141 quad_perm:[0,0,0,0] row_mask:0xf bank_mask:0xf
    v_add_f32_dpp v145, v144, v145 quad_perm:[0,0,0,0] row_mask:0xf bank_mask:0xf
    v_add_f32_dpp v149, v148, v149 quad_perm:[0,0,0,0] row_mask:0xf bank_mask:0xf
    v_add_f32_dpp v27, v26, v27 quad_perm:[2,2,2,2] row_mask:0xf bank_mask:0xf
    v_add_f32_dpp v31, v30, v31 quad_perm:[2,2,2,2] row_mask:0xf bank_mask:0xf
    v_add_f32_dpp v131, v130, v131 quad_perm:[2,2,2,2] row_mask:0xf bank_mask:0xf
    v_add_f32_dpp v135, v134, v135 quad_perm:[2,2,2,2] row_mask:0xf bank_mask:0xf
    v_add_f32_dpp v139, v138, v139 quad_perm:[2,2,2,2] row_mask:0xf bank_mask:0xf
    v_add_f32_dpp v143, v142, v143 quad_perm:[2,2,2,2] row_mask:0xf bank_mask:0xf
    v_add_f32_dpp v147, v146, v147 quad_perm:[2,2,2,2] row_mask:0xf bank_mask:0xf
    v_add_f32_dpp v151, v150, v151 quad_perm:[2,2,2,2] row_mask:0xf bank_mask:0xf
    v_add_f32_dpp v152, v25, v27 quad_perm:[1,1,1,1] row_mask:0xf bank_mask:0xf
    v_add_f32_dpp v153, v29, v31 quad_perm:[1,1,1,1] row_mask:0xf bank_mask:0xf
    v_add_f32_dpp v154, v129, v131 quad_perm:[1,1,1,1] row_mask:0xf bank_mask:0xf
    v_add_f32_dpp v155, v133, v135 quad_perm:[1,1,1,1] row_mask:0xf bank_mask:0xf
    v_add_f32_dpp v156, v137, v139 quad_perm:[1,1,1,1] row_mask:0xf bank_mask:0xf
    v_add_f32_dpp v157, v141, v143 quad_perm:[1,1,1,1] row_mask:0xf bank_mask:0xf
    v_add_f32_dpp v158, v145, v147 quad_perm:[1,1,1,1] row_mask:0xf bank_mask:0xf
    v_add_f32_dpp v159, v149, v151 quad_perm:[1,1,1,1] row_mask:0xf bank_mask:0xf
    v_cvt_pk_bf16_f32 v152, 0, v152
    v_cvt_pk_bf16_f32 v153, 0, v153
    v_cvt_pk_bf16_f32 v154, 0, v154
    v_cvt_pk_bf16_f32 v155, 0, v155
    v_cvt_pk_bf16_f32 v156, 0, v156
    v_cvt_pk_bf16_f32 v157, 0, v157
    v_cvt_pk_bf16_f32 v158, 0, v158
    v_cvt_pk_bf16_f32 v159, 0, v159
    v_mul_f32 v152, s80, v152
    v_mul_f32 v153, s80, v153
    v_mul_f32 v154, s80, v154
    v_mul_f32 v155, s80, v155
    v_mul_f32 v156, s80, v156
    v_mul_f32 v157, s80, v157
    v_mul_f32 v158, s80, v158
    v_mul_f32 v159, s80, v159
    v_cvt_pk_bf16_f32 v152, 0, v152
    v_cvt_pk_bf16_f32 v153, 0, v153
    v_cvt_pk_bf16_f32 v154, 0, v154
    v_cvt_pk_bf16_f32 v155, 0, v155
    v_cvt_pk_bf16_f32 v156, 0, v156
    v_cvt_pk_bf16_f32 v157, 0, v157
    v_cvt_pk_bf16_f32 v158, 0, v158
    v_cvt_pk_bf16_f32 v159, 0, v159
    v_max3_f32 v20, v152, v153, v154
    v_max3_f32 v21, v155, v156, v157
    v_max3_f32 v20, v20, v158, v159
    v_max_f32 v20, v20, v21
    v_cmp_gt_f32 vcc, v20, v8
    s_and_b64 vcc, vcc, s[84:85]
    s_cbranch_execz Lf_9s
    s_cbranch_scc0 Lf_9
Lf_9s:
    v_max_f32 v20, v20, v3
    v_mov_b32 v21, v20
    s_nop 1
    v_permlane32_swap_b32 v20, v21
    v_max_f32 v20, v20, v21
    v_mov_b32 v21, v20
    s_nop 1
    v_permlane16_swap_b32 v20, v21
    v_max_f32 v3, v20, v21
    v_mul_f32 v21, 0xbfb8aa3b, v3
    v_add_f32 v8, 0x41000000, v3
    v_sub_f32 v20, v21, v6
    v_min_f32 v20, 0, v20
    v_exp_f32 v20, v20
    v_mov_b32 v6, v21
    v_mul_f32 v4, v4, v20
    v_mul_f32 v5, v5, v20
    v_mul_f32 v32, v32, v20
    v_mul_f32 v33, v33, v20
    v_mul_f32 v34, v34, v20
    v_mul_f32 v35, v35, v20
    v_mul_f32 v36, v36, v20
    v_mul_f32 v37, v37, v20
    v_mul_f32 v38, v38, v20
    v_mul_f32 v39, v39, v20
    v_mul_f32 v40, v40, v20
    v_mul_f32 v41, v41, v20
    v_mul_f32 v42, v42, v20
    v_mul_f32 v43, v43, v20
    v_mul_f32 v44, v44, v20
    v_mul_f32 v45, v45, v20
    v_mul_f32 v46, v46, v20
    v_mul_f32 v47, v47, v20
    v_mul_f32 v48, v48, v20
    v_mul_f32 v49, v49, v20
    v_mul_f32 v50, v50, v20
    v_mul_f32 v51, v51, v20
    v_mul_f32 v52, v52, v20
    v_mul_f32 v53, v53, v20
    v_mul_f32 v54, v54, v20
    v_mul_f32 v55, v55, v20
    v_mul_f32 v56, v56, v20
    v_mul_f32 v57, v57, v20
    v_mul_f32 v58, v58, v20
    v_mul_f32 v59, v59, v20
    v_mul_f32 v60, v60, v20
    v_mul_f32 v61, v61, v20
    v_mul_f32 v62, v62, v20
    v_mul_f32 v63, v63, v20
Lf_9:
    v_fma_f32 v152, v152, s82, v6
    v_fma_f32 v153, v153, s82, v6
    v_fma_f32 v154, v154, s82, v6
    v_fma_f32 v155, v155, s82, v6
    v_fma_f32 v156, v156, s82, v6
    v_fma_f32 v157, v157, s82, v6
    v_fma_f32 v158, v158, s82, v6
    v_fma_f32 v159, v159, s82, v6
    v_exp_f32 v152, v152
    v_exp_f32 v153, v153
    v_exp_f32 v154, v154
    v_exp_f32 v155, v155
    v_exp_f32 v156, v156
    v_exp_f32 v157, v157
    v_exp_f32 v158, v158
    v_exp_f32 v159, v159
    v_cvt_pk_bf16_f32 v16, v152, v153
    v_cvt_pk_bf16_f32 v17, v154, v155
    v_cvt_pk_bf16_f32 v18, v156, v157
    v_cvt_pk_bf16_f32 v19, v158, v159
    v_add_f32 v4, v4, v152
    v_add_f32 v5, v5, v153
    v_add_f32 v4, v4, v154
    v_add_f32 v5, v5, v155
    v_add_f32 v4, v4, v156
    v_add_f32 v5, v5, v157
    v_add_f32 v4, v4, v158
    v_add_f32 v5, v5, v159
    s_waitcnt vmcnt(8)
    s_cmp_lg_u32 s29, 0
    s_cbranch_scc1 Lw_10e
    s_cbranch_execz Lw_10
    buffer_load_dwordx4 v[96:99], v2, s[8:11], s27 offen offset:0 nt
    buffer_load_dwordx4 v[100:103], v2, s[8:11], s27 offen offset:1024 nt
    buffer_load_dwordx4 v[104:107], v2, s[8:11], s27 offen offset:2048 nt
    buffer_load_dwordx4 v[108:111], v2, s[8:11], s27 offen offset:3072 nt
    buffer_load_dwordx4 v[112:115], v2, s[8:11], s28 offen offset:0 nt
    buffer_load_dwordx4 v[116:119], v2, s[8:11], s28 offen offset:1024 nt
    buffer_load_dwordx4 v[120:123], v2, s[8:11], s28 offen offset:2048 nt
    buffer_load_dwordx4 v[124:127], v2, s[8:11], s28 offen offset:3072 nt
Lw_10:
Lw_10f:
    v_perm_b32 v128, v164, v160, s77
    v_perm_b32 v129, v172, v168, s77
    v_perm_b32 v130, v180, v176, s77
    v_perm_b32 v131, v188, v184, s77
    v_perm_b32 v132, v164, v160, s78
    v_perm_b32 v133, v172, v168, s78
    v_perm_b32 v134, v180, v176, s78
    v_perm_b32 v135, v188, v184, s78
    v_perm_b32 v136, v165, v161, s77
    v_perm_b32 v137, v173, v169, s77
    v_perm_b32 v138, v181, v177, s77
    v_perm_b32 v139, v189, v185, s77
    v_perm_b32 v140, v165, v161, s78
    v_perm_b32 v141, v173, v169, s78
    v_perm_b32 v142, v181, v177, s78
    v_perm_b32 v143, v189, v185, s78
    v_mfma_f32_16x16x32_bf16 v[32:35], v[128:131], v[16:19], v[32:35]
    v_mfma_f32_16x16x32_bf16 v[36:39], v[132:135], v[16:19], v[36:39]
    v_perm_b32 v144, v166, v162, s77
    v_perm_b32 v145, v174, v170, s77
    v_perm_b32 v146, v182, v178, s77
    v_perm_b32 v147, v190, v186, s77
    v_perm_b32 v148, v166, v162, s78
    v_perm_b32 v149, v174, v170, s78
    v_perm_b32 v150, v182, v178, s78
    v_perm_b32 v151, v190, v186, s78
    v_mfma_f32_16x16x32_bf16 v[40:43], v[136:139], v[16:19], v[40:43]
    v_mfma_f32_16x16x32_bf16 v[44:47], v[140:143], v[16:19], v[44:47]
    v_perm_b32 v152, v167, v163, s77
    v_perm_b32 v153, v175, v171, s77
    v_perm_b32 v154, v183, v179, s77
    v_perm_b32 v155, v191, v187, s77
    v_perm_b32 v156, v167, v163, s78
    v_perm_b32 v157, v175, v171, s78
    v_perm_b32 v158, v183, v179, s78
    v_perm_b32 v159, v191, v187, s78
    v_mfma_f32_16x16x32_bf16 v[48:51], v[144:147], v[16:19], v[48:51]
    v_mfma_f32_16x16x32_bf16 v[52:55], v[148:151], v[16:19], v[52:55]
    ds_read_b32 v9, v7 offset:1536
    v_mfma_f32_16x16x32_bf16 v[56:59], v[152:155], v[16:19], v[56:59]
    v_mfma_f32_16x16x32_bf16 v[60:63], v[156:159], v[16:19], v[60:63]
    s_cbranch_execz L_dryret
    s_cmp_eq_u32 s29, 0
    s_cbranch_scc1 L_loop
L_sdone:
    v_add_f32 v4, v4, v5
    v_mov_b32 v5, v4
    v_bfe_u32 v20, v0, 2, 2
    v_lshrrev_b32 v21, 4, v0
    v_permlane32_swap_b32 v4, v5
    v_add_f32 v4, v4, v5
    v_mov_b32 v5, v4
    v_lshlrev_b32 v22, 9, v20
    v_lshl_add_u32 v22, v21, 4, v22
    v_permlane16_swap_b32 v4, v5
    v_add_f32 v4, v4, v5
    s_lshl_b32 s30, s3, 11
    v_add_u32 v22, s30, v22
    s_lshl_b32 s30, s3, 2
    v_lshl_add_u32 v23, v20, 4, s30
    s_and_b32 exec_lo, s60, 0x88888888
    s_and_b32 exec_hi, s61, 0x88888888
    ds_write_b32 v23, v3 offset:12288
    ds_write_b32 v23, v4 offset:12352
    ds_write_b128 v22, v[32:35] offset:4096
    ds_write_b128 v22, v[36:39] offset:4160
    ds_write_b128 v22, v[40:43] offset:4224
    ds_write_b128 v22, v[44:47] offset:4288
    ds_write_b128 v22, v[48:51] offset:4352
    ds_write_b128 v22, v[52:55] offset:4416
    ds_write_b128 v22, v[56:59] offset:4480
    ds_write_b128 v22, v[60:63] offset:4544
    s_and_b64 exec, s[60:61], 1
    v_mov_b32 v20, 1
    ds_add_rtn_u32 v20, v10, v20 offset:48
    s_mov_b64 exec, s[60:61]
    v_lshrrev_b32 v21, 5, v0
    v_lshlrev_b32 v23, 4, v21
    ds_read_b128 v[96:99], v23 offset:12288
    ds_read_b128 v[100:103], v23 offset:12352
    ds_read_b128 v[104:107], v23 offset:12320
    ds_read_b128 v[108:111], v23 offset:12384
    ds_read_b128 v[64:67], v2 offset:4096
    ds_read_b128 v[68:71], v2 offset:6144
    ds_read_b128 v[72:75], v2 offset:8192
    ds_read_b128 v[76:79], v2 offset:10240
    ds_read_b128 v[80:83], v2 offset:5120
    ds_read_b128 v[84:87], v2 offset:7168
    ds_read_b128 v[88:91], v2 offset:9216
    ds_read_b128 v[92:95], v2 offset:11264
    v_mov_b32 v16, s79
    v_lshrrev_b32 v17, 8, v16
    v_lshrrev_b32 v18, 16, v16
    v_lshrrev_b32 v19, 24, v16
    v_and_b32 v22, 31, v0
    v_lshlrev_b32 v22, 4, v22
    v_lshl_add_u32 v22, v21, 14, v22
    v_and_b32 v23, 1, v0
    v_lshlrev_b32 v23, 10, v23
    v_lshl_add_u32 v23, v21, 9, v23
    s_lshl_b32 s92, s24, 16
    s_lshl_b32 s31, s25, 9
    s_add_u32 s92, s92, s31
    s_add_u32 s92, s92, 131072
    s_add_u32 s93, s92, 0x8000
    s_lshl_b32 s94, s24, 11
    s_lshl_b32 s31, s25, 4
    s_add_u32 s94, s94, s31
    s_add_u32 s94, s94, 655360
    s_waitcnt lgkmcnt(12)
    v_readfirstlane_b32 s30, v20
    s_cbranch_execz L_t1
    s_cmp_lg_u32 s30, 3
    s_cbranch_scc1 L_exit4
L_t1:
    s_waitcnt lgkmcnt(8)
    v_max3_f32 v24, v96, v97, v98
    v_max3_f32 v28, v104, v105, v106
    v_max_f32 v24, v24, v99
    v_max_f32 v28, v28, v107
    v_mul_f32 v26, s82, v24
    v_mul_f32 v30, s82, v28
    v_mul_f32 v96, s82, v96
    v_mul_f32 v97, s82, v97
    v_mul_f32 v98, s82, v98
    v_mul_f32 v99, s82, v99
    v_mul_f32 v104, s82, v104
    v_mul_f32 v105, s82, v105
    v_mul_f32 v106, s82, v106
    v_mul_f32 v107, s82, v107
    v_sub_f32 v96, v96, v26
    v_sub_f32 v97, v97, v26
    v_sub_f32 v98, v98, v26
    v_sub_f32 v99, v99, v26
    v_sub_f32 v104, v104, v30
    v_sub_f32 v105, v105, v30
    v_sub_f32 v106, v106, v30
    v_sub_f32 v107, v107, v30
    v_exp_f32 v96, v96
    v_exp_f32 v97, v97
    v_exp_f32 v98, v98
    v_exp_f32 v99, v99
    v_exp_f32 v104, v104
    v_exp_f32 v105, v105
    v_exp_f32 v106, v106
    v_exp_f32 v107, v107
    s_waitcnt lgkmcnt(4)
    v_mul_f32 v64, v96, v64
    v_mul_f32 v65, v96, v65
    v_mul_f32 v66, v96, v66
    v_mul_f32 v67, v96, v67
    v_fmac_f32 v64, v97, v68
    v_fmac_f32 v65, v97, v69
    v_fmac_f32 v66, v97, v70
    v_fmac_f32 v67, v97, v71
    v_fmac_f32 v64, v98, v72
    v_fmac_f32 v65, v98, v73
    v_fmac_f32 v66, v98, v74
    v_fmac_f32 v67, v98, v75
    v_fmac_f32 v64, v99, v76
    v_fmac_f32 v65, v99, v77
    v_fmac_f32 v66, v99, v78
    v_fmac_f32 v67, v99, v79
    v_bfi_b32 v64, s76, v16, v64
    v_bfi_b32 v65, s76, v17, v65
    v_bfi_b32 v66, s76, v18, v66
    v_bfi_b32 v67, s76, v19, v67
    s_cbranch_execz Ls_11
    buffer_store_dwordx4 v[64:67], v22, s[12:15], s92 offen sc1
Ls_11:
    s_waitcnt lgkmcnt(0)
    v_mul_f32 v80, v104, v80
    v_mul_f32 v81, v104, v81
    v_mul_f32 v82, v104, v82
    v_mul_f32 v83, v104, v83
    v_fmac_f32 v80, v105, v84
    v_fmac_f32 v81, v105, v85
    v_fmac_f32 v82, v105, v86
    v_fmac_f32 v83, v105, v87
    v_fmac_f32 v80, v106, v88
    v_fmac_f32 v81, v106, v89
    v_fmac_f32 v82, v106, v90
    v_fmac_f32 v83, v106, v91
    v_fmac_f32 v80, v107, v92
    v_fmac_f32 v81, v107, v93
    v_fmac_f32 v82, v107, v94
    v_fmac_f32 v83, v107, v95
    v_bfi_b32 v80, s76, v16, v80
    v_bfi_b32 v81, s76, v17, v81
    v_bfi_b32 v82, s76, v18, v82
    v_bfi_b32 v83, s76, v19, v83
    s_cbranch_execz Ls_12
    buffer_store_dwordx4 v[80:83], v22, s[12:15], s93 offen sc1
Ls_12:
    v_mul_f32 v25, v96, v100
    v_mul_f32 v29, v104, v108
    v_fmac_f32 v25, v97, v101
    v_fmac_f32 v29, v105, v109
    v_fmac_f32 v25, v98, v102
    v_fmac_f32 v29, v106, v110
    v_fmac_f32 v25, v99, v103
    v_fmac_f32 v29, v107, v111
    s_and_b32 exec_lo, s60, 0x2
    s_and_b32 exec_hi, s61, 0x2
    v_mov_b32 v24, v28
    v_mov_b32 v25, v29
    s_and_b32 exec_lo, s60, 0x3
    s_and_b32 exec_hi, s61, 0x3
    v_bfi_b32 v24, s76, v16, v24
    v_bfi_b32 v25, s76, v17, v25
    v_bfi_b32 v26, s76, v18, v26
    v_bfi_b32 v27, s76, v19, v27
    s_cbranch_execz L_t2
    buffer_store_dwordx4 v[24:27], v23, s[12:15], s94 offen sc1
L_exit4:
    s_add_u32 s3, s3, 4
    s_branch L_exit
Lk_5x:
    s_cmp_eq_u32 s30, -1
    s_cbranch_scc0 Lk_5e
    s_sleep 1
    ds_read_b32 v9, v7 offset:1536
    s_sub_u32 s63, s63, 1
    s_cmp_lg_u32 s63, 0
    s_waitcnt lgkmcnt(0)
    s_cbranch_scc1 Lk_5r
Lk_5e:
    s_mov_b32 s29, 1
    s_branch Lk_5
Lw_7e:
    s_waitcnt vmcnt(0)
    s_branch Lw_7f
Lk_8x:
    s_cmp_eq_u32 s30, -1
    s_cbranch_scc0 Lk_8e
    s_sleep 1
    ds_read_b32 v9, v7 offset:1536
    s_sub_u32 s63, s63, 1
    s_cmp_lg_u32 s63, 0
    s_waitcnt lgkmcnt(0)
    s_cbranch_scc1 Lk_8r
Lk_8e:
    s_mov_b32 s29, 1
    s_branch Lk_8
Lw_10e:
    s_waitcnt vmcnt(0)
    s_branch Lw_10f
L_t2:
    s_mov_b64 exec, s[60:61]
    v_and_b32 v23, 31, v0
    v_lshlrev_b32 v23, 3, v23
    v_lshrrev_b32 v22, 5, v0
    v_lshl_add_u32 v23, v22, 2, v23
    s_lshl_b32 s31, s3, 8
    v_add_u32 v23, s31, v23
    v_lshrrev_b32 v22, 4, v0
    v_lshlrev_b32 v22, 4, v22
    v_and_b32 v16, 1, v0
    v_lshl_add_u32 v16, v16, 6, v22
    v_add_u32 v16, s31, v16
    v_lshrrev_b32 v17, 5, v0
    v_lshlrev_b32 v17, 8, v17
    v_bfe_u32 v18, v0, 4, 1
    v_lshl_add_u32 v17, v18, 4, v17
    s_lshl_b32 s31, s3, 9
    v_add_u32 v17, s31, v17
    v_and_b32 v21, 15, v0
    v_lshlrev_b32 v21, 5, v21
    v_lshrrev_b32 v18, 5, v0
    v_lshl_add_u32 v21, v18, 4, v21
    s_lshl_b32 s30, s24, 2
    s_add_u32 s30, s30, s3
    s_lshl_b32 s96, s30, 9
    s_add_u32 s96, s96, 655360
    s_lshl_b32 s92, s30, 14
    s_add_u32 s92, s92, 131072
    s_bfe_u32 s97, s25, 0x20001
    s_lshl_b32 s97, s97, 12
    s_lshl_b32 s31, s24, 9
    s_add_u32 s97, s97, s31
    s_and_b32 s31, s25, 1
    s_lshl_b32 s31, s31, 5
    s_add_u32 s97, s97, s31
    s_add_u32 s97, s97, 720896
    v_bfe_u32 v1, v0, 1, 3
    v_lshlrev_b32 v1, 6, v1
    v_and_b32 v18, 1, v0
    v_lshl_add_u32 v1, v18, 4, v1
    v_and_b32 v18, 15, v0
    v_lshlrev_b32 v18, 4, v18
    v_lshrrev_b32 v19, 4, v0
    v_lshl_add_u32 v18, v19, 9, v18
    v_mov_b32 v19, 1
    s_add_u32 s93, s92, 4096
    s_add_u32 s94, s92, 8192
    s_add_u32 s95, s92, 12288
    s_cbranch_execz Lpd_14
    s_mov_b32 s63, 1000000
Lp_13:
    buffer_load_dwordx4 v[28:31], v21, s[12:15], s96 offen sc1
    s_waitcnt vmcnt(0)
    v_xor_b32 v20, v28, v4
    v_bitop3_b32 v20, v20, v29, v5 bitop3:0xf6
    v_bitop3_b32 v20, v20, v30, v6 bitop3:0xf6
    v_bitop3_b32 v20, v20, v31, v7 bitop3:0xf6
    v_and_b32 v20, 0xff, v20
    v_cmp_eq_u32 vcc, 0, v20
    s_bcnt1_i32_b64 s30, vcc
    s_cmp_ge_u32 s30, 24
    s_cbranch_scc1 Lpd_14
    s_sub_u32 s63, s63, 1
    s_cmp_lg_u32 s63, 0
    s_cbranch_scc1 Lp_13
Lpd_14:
    s_mov_b64 s[64:65], s[60:61]
    s_mov_b64 s[66:67], s[60:61]
    s_mov_b64 s[68:69], s[60:61]
    s_mov_b64 s[70:71], s[60:61]
    s_mov_b64 s[72:73], s[60:61]
    s_mov_b64 s[74:75], s[60:61]
    s_mov_b64 s[32:33], s[60:61]
    s_mov_b64 s[34:35], s[60:61]
    s_mov_b64 s[36:37], s[60:61]
    s_mov_b32 s63, 1000000
Lg_15:
    s_mov_b64 exec, s[64:65]
    s_cbranch_execz Ls_17
    buffer_load_dwordx4 v[64:67], v2, s[12:15], s92 offen offset:0 sc1
    buffer_load_dwordx4 v[68:71], v2, s[12:15], s92 offen offset:1024 sc1
Ls_17:
    s_mov_b64 exec, s[66:67]
    s_cbranch_execz Ls_18
    buffer_load_dwordx4 v[72:75], v2, s[12:15], s92 offen offset:2048 sc1
    buffer_load_dwordx4 v[76:79], v2, s[12:15], s92 offen offset:3072 sc1
Ls_18:
    s_mov_b64 exec, s[68:69]
    s_cbranch_execz Ls_19
    buffer_load_dwordx4 v[80:83], v2, s[12:15], s93 offen offset:0 sc1
    buffer_load_dwordx4 v[84:87], v2, s[12:15], s93 offen offset:1024 sc1
Ls_19:
    s_mov_b64 exec, s[70:71]
    s_cbranch_execz Ls_20
    buffer_load_dwordx4 v[88:91], v2, s[12:15], s93 offen offset:2048 sc1
    buffer_load_dwordx4 v[92:95], v2, s[12:15], s93 offen offset:3072 sc1
Ls_20:
    s_mov_b64 exec, s[72:73]
    s_cbranch_execz Ls_21
    buffer_load_dwordx4 v[96:99], v2, s[12:15], s94 offen offset:0 sc1
    buffer_load_dwordx4 v[100:103], v2, s[12:15], s94 offen offset:1024 sc1
Ls_21:
    s_mov_b64 exec, s[74:75]
    s_cbranch_execz Ls_22
    buffer_load_dwordx4 v[104:107], v2, s[12:15], s94 offen offset:2048 sc1
    buffer_load_dwordx4 v[108:111], v2, s[12:15], s94 offen offset:3072 sc1
Ls_22:
    s_mov_b64 exec, s[32:33]
    s_cbranch_execz Ls_23
    buffer_load_dwordx4 v[112:115], v2, s[12:15], s95 offen offset:0 sc1
    buffer_load_dwordx4 v[116:119], v2, s[12:15], s95 offen offset:1024 sc1
Ls_23:
    s_mov_b64 exec, s[34:35]
    s_cbranch_execz Ls_24
    buffer_load_dwordx4 v[120:123], v2, s[12:15], s95 offen offset:2048 sc1
    buffer_load_dwordx4 v[124:127], v2, s[12:15], s95 offen offset:3072 sc1
Ls_24:
    s_mov_b64 exec, s[36:37]
    s_cbranch_execz Ls_25
    buffer_load_dwordx4 v[28:31], v21, s[12:15], s96 offen offset:0 sc1
Ls_25:
    s_mov_b64 s[86:87], 0
    s_waitcnt vmcnt(0)
    s_mov_b64 exec, s[64:65]
    s_cbranch_execz Ls_26
    v_xor_b32 v20, v64, v4
    v_bitop3_b32 v20, v20, v65, v5 bitop3:0xf6
    v_bitop3_b32 v20, v20, v66, v6 bitop3:0xf6
    v_bitop3_b32 v20, v20, v67, v7 bitop3:0xf6
    v_bitop3_b32 v20, v20, v68, v4 bitop3:0xf6
    v_bitop3_b32 v20, v20, v69, v5 bitop3:0xf6
    v_bitop3_b32 v20, v20, v70, v6 bitop3:0xf6
    v_bitop3_b32 v20, v20, v71, v7 bitop3:0xf6
    v_and_b32 v20, 0xff, v20
    v_cmp_ne_u32 s[64:65], 0, v20
    s_or_b64 s[86:87], s[86:87], s[64:65]
Ls_26:
    s_mov_b64 exec, s[66:67]
    s_cbranch_execz Ls_27
    v_xor_b32 v20, v72, v4
    v_bitop3_b32 v20, v20, v73, v5 bitop3:0xf6
    v_bitop3_b32 v20, v20, v74, v6 bitop3:0xf6
    v_bitop3_b32 v20, v20, v75, v7 bitop3:0xf6
    v_bitop3_b32 v20, v20, v76, v4 bitop3:0xf6
    v_bitop3_b32 v20, v20, v77, v5 bitop3:0xf6
    v_bitop3_b32 v20, v20, v78, v6 bitop3:0xf6
    v_bitop3_b32 v20, v20, v79, v7 bitop3:0xf6
    v_and_b32 v20, 0xff, v20
    v_cmp_ne_u32 s[66:67], 0, v20
    s_or_b64 s[86:87], s[86:87], s[66:67]
Ls_27:
    s_mov_b64 exec, s[68:69]
    s_cbranch_execz Ls_28
    v_xor_b32 v20, v80, v4
    v_bitop3_b32 v20, v20, v81, v5 bitop3:0xf6
    v_bitop3_b32 v20, v20, v82, v6 bitop3:0xf6
    v_bitop3_b32 v20, v20, v83, v7 bitop3:0xf6
    v_bitop3_b32 v20, v20, v84, v4 bitop3:0xf6
    v_bitop3_b32 v20, v20, v85, v5 bitop3:0xf6
    v_bitop3_b32 v20, v20, v86, v6 bitop3:0xf6
    v_bitop3_b32 v20, v20, v87, v7 bitop3:0xf6
    v_and_b32 v20, 0xff, v20
    v_cmp_ne_u32 s[68:69], 0, v20
    s_or_b64 s[86:87], s[86:87], s[68:69]
Ls_28:
    s_mov_b64 exec, s[70:71]
    s_cbranch_execz Ls_29
    v_xor_b32 v20, v88, v4
    v_bitop3_b32 v20, v20, v89, v5 bitop3:0xf6
    v_bitop3_b32 v20, v20, v90, v6 bitop3:0xf6
    v_bitop3_b32 v20, v20, v91, v7 bitop3:0xf6
    v_bitop3_b32 v20, v20, v92, v4 bitop3:0xf6
    v_bitop3_b32 v20, v20, v93, v5 bitop3:0xf6
    v_bitop3_b32 v20, v20, v94, v6 bitop3:0xf6
    v_bitop3_b32 v20, v20, v95, v7 bitop3:0xf6
    v_and_b32 v20, 0xff, v20
    v_cmp_ne_u32 s[70:71], 0, v20
    s_or_b64 s[86:87], s[86:87], s[70:71]
Ls_29:
    s_mov_b64 exec, s[72:73]
    s_cbranch_execz Ls_30
    v_xor_b32 v20, v96, v4
    v_bitop3_b32 v20, v20, v97, v5 bitop3:0xf6
    v_bitop3_b32 v20, v20, v98, v6 bitop3:0xf6
    v_bitop3_b32 v20, v20, v99, v7 bitop3:0xf6
    v_bitop3_b32 v20, v20, v100, v4 bitop3:0xf6
    v_bitop3_b32 v20, v20, v101, v5 bitop3:0xf6
    v_bitop3_b32 v20, v20, v102, v6 bitop3:0xf6
    v_bitop3_b32 v20, v20, v103, v7 bitop3:0xf6
    v_and_b32 v20, 0xff, v20
    v_cmp_ne_u32 s[72:73], 0, v20
    s_or_b64 s[86:87], s[86:87], s[72:73]
Ls_30:
    s_mov_b64 exec, s[74:75]
    s_cbranch_execz Ls_31
    v_xor_b32 v20, v104, v4
    v_bitop3_b32 v20, v20, v105, v5 bitop3:0xf6
    v_bitop3_b32 v20, v20, v106, v6 bitop3:0xf6
    v_bitop3_b32 v20, v20, v107, v7 bitop3:0xf6
    v_bitop3_b32 v20, v20, v108, v4 bitop3:0xf6
    v_bitop3_b32 v20, v20, v109, v5 bitop3:0xf6
    v_bitop3_b32 v20, v20, v110, v6 bitop3:0xf6
    v_bitop3_b32 v20, v20, v111, v7 bitop3:0xf6
    v_and_b32 v20, 0xff, v20
    v_cmp_ne_u32 s[74:75], 0, v20
    s_or_b64 s[86:87], s[86:87], s[74:75]
Ls_31:
    s_mov_b64 exec, s[32:33]
    s_cbranch_execz Ls_32
    v_xor_b32 v20, v112, v4
    v_bitop3_b32 v20, v20, v113, v5 bitop3:0xf6
    v_bitop3_b32 v20, v20, v114, v6 bitop3:0xf6
    v_bitop3_b32 v20, v20, v115, v7 bitop3:0xf6
    v_bitop3_b32 v20, v20, v116, v4 bitop3:0xf6
    v_bitop3_b32 v20, v20, v117, v5 bitop3:0xf6
    v_bitop3_b32 v20, v20, v118, v6 bitop3:0xf6
    v_bitop3_b32 v20, v20, v119, v7 bitop3:0xf6
    v_and_b32 v20, 0xff, v20
    v_cmp_ne_u32 s[32:33], 0, v20
    s_or_b64 s[86:87], s[86:87], s[32:33]
Ls_32:
    s_mov_b64 exec, s[34:35]
    s_cbranch_execz Ls_33
    v_xor_b32 v20, v120, v4
    v_bitop3_b32 v20, v20, v121, v5 bitop3:0xf6
    v_bitop3_b32 v20, v20, v122, v6 bitop3:0xf6
    v_bitop3_b32 v20, v20, v123, v7 bitop3:0xf6
    v_bitop3_b32 v20, v20, v124, v4 bitop3:0xf6
    v_bitop3_b32 v20, v20, v125, v5 bitop3:0xf6
    v_bitop3_b32 v20, v20, v126, v6 bitop3:0xf6
    v_bitop3_b32 v20, v20, v127, v7 bitop3:0xf6
    v_and_b32 v20, 0xff, v20
    v_cmp_ne_u32 s[34:35], 0, v20
    s_or_b64 s[86:87], s[86:87], s[34:35]
Ls_33:
    s_mov_b64 exec, s[36:37]
    s_cbranch_execz Ls_34
    v_xor_b32 v20, v28, v4
    v_bitop3_b32 v20, v20, v29, v5 bitop3:0xf6
    v_bitop3_b32 v20, v20, v30, v6 bitop3:0xf6
    v_bitop3_b32 v20, v20, v31, v7 bitop3:0xf6
    v_and_b32 v20, 0xff, v20
    v_cmp_ne_u32 s[36:37], 0, v20
    s_or_b64 s[86:87], s[86:87], s[36:37]
Ls_34:
    s_cmp_eq_u64 s[86:87], 0
    s_cbranch_scc1 Lgd_16
    s_sub_u32 s63, s63, 1
    s_cmp_lg_u32 s63, 0
    s_cbranch_scc1 Lg_15
Lgd_16:
    s_mov_b64 exec, s[60:61]
    v_and_b32 v26, 0xffff0000, v28
    v_and_b32 v24, 0xffff0000, v28
    s_nop 1
    v_max_f32_dpp v24, v24, v24 row_ror:8 row_mask:0xf bank_mask:0xf
    s_nop 1
    v_max_f32_dpp v24, v24, v24 row_ror:4 row_mask:0xf bank_mask:0xf
    s_nop 1
    v_max_f32_dpp v24, v24, v24 row_ror:2 row_mask:0xf bank_mask:0xf
    s_nop 1
    v_max_f32_dpp v24, v24, v24 row_ror:1 row_mask:0xf bank_mask:0xf
    v_mov_b32 v25, v24
    v_mul_f32 v26, 0x3fb8aa3b, v26
    s_nop 0
    v_permlane32_swap_b32 v24, v25
    v_max_f32 v24, v24, v25
    v_mul_f32 v24, 0x3fb8aa3b, v24
    v_sub_f32 v26, v26, v24
    v_exp_f32 v26, v26
    s_nop 0
    v_mul_f32 v24, v26, v29
    v_mul_f32_dpp v32, v26, v64 row_newbcast:0 row_mask:0xf bank_mask:0xf
    v_mul_f32_dpp v33, v26, v65 row_newbcast:0 row_mask:0xf bank_mask:0xf
    v_mul_f32_dpp v34, v26, v66 row_newbcast:0 row_mask:0xf bank_mask:0xf
    v_mul_f32_dpp v35, v26, v67 row_newbcast:0 row_mask:0xf bank_mask:0xf
    v_mul_f32_dpp v36, v26, v68 row_newbcast:1 row_mask:0xf bank_mask:0xf
    v_mul_f32_dpp v37, v26, v69 row_newbcast:1 row_mask:0xf bank_mask:0xf
    v_mul_f32_dpp v38, v26, v70 row_newbcast:1 row_mask:0xf bank_mask:0xf
    v_mul_f32_dpp v39, v26, v71 row_newbcast:1 row_mask:0xf bank_mask:0xf
    v_fmac_f32_dpp v32, v26, v72 row_newbcast:2 row_mask:0xf bank_mask:0xf
    v_fmac_f32_dpp v33, v26, v73 row_newbcast:2 row_mask:0xf bank_mask:0xf
    v_fmac_f32_dpp v34, v26, v74 row_newbcast:2 row_mask:0xf bank_mask:0xf
    v_fmac_f32_dpp v35, v26, v75 row_newbcast:2 row_mask:0xf bank_mask:0xf
    v_add_f32_dpp v24, v24, v24 row_ror:8 row_mask:0xf bank_mask:0xf
    v_fmac_f32_dpp v36, v26, v76 row_newbcast:3 row_mask:0xf bank_mask:0xf
    v_fmac_f32_dpp v37, v26, v77 row_newbcast:3 row_mask:0xf bank_mask:0xf
    v_fmac_f32_dpp v38, v26, v78 row_newbcast:3 row_mask:0xf bank_mask:0xf
    v_fmac_f32_dpp v39, v26, v79 row_newbcast:3 row_mask:0xf bank_mask:0xf
    v_add_f32_dpp v24, v24, v24 row_ror:4 row_mask:0xf bank_mask:0xf
    v_fmac_f32_dpp v32, v26, v80 row_newbcast:4 row_mask:0xf bank_mask:0xf
    v_fmac_f32_dpp v33, v26, v81 row_newbcast:4 row_mask:0xf bank_mask:0xf
    v_fmac_f32_dpp v34, v26, v82 row_newbcast:4 row_mask:0xf bank_mask:0xf
    v_fmac_f32_dpp v35, v26, v83 row_newbcast:4 row_mask:0xf bank_mask:0xf
    v_add_f32_dpp v24, v24, v24 row_ror:2 row_mask:0xf bank_mask:0xf
    v_fmac_f32_dpp v36, v26, v84 row_newbcast:5 row_mask:0xf bank_mask:0xf
    v_fmac_f32_dpp v37, v26, v85 row_newbcast:5 row_mask:0xf bank_mask:0xf
    v_fmac_f32_dpp v38, v26, v86 row_newbcast:5 row_mask:0xf bank_mask:0xf
    v_fmac_f32_dpp v39, v26, v87 row_newbcast:5 row_mask:0xf bank_mask:0xf
    v_add_f32_dpp v24, v24, v24 row_ror:1 row_mask:0xf bank_mask:0xf
    v_fmac_f32_dpp v32, v26, v88 row_newbcast:6 row_mask:0xf bank_mask:0xf
    v_fmac_f32_dpp v33, v26, v89 row_newbcast:6 row_mask:0xf bank_mask:0xf
    v_fmac_f32_dpp v34, v26, v90 row_newbcast:6 row_mask:0xf bank_mask:0xf
    v_fmac_f32_dpp v35, v26, v91 row_newbcast:6 row_mask:0xf bank_mask:0xf
    v_mov_b32 v25, v24
    v_fmac_f32_dpp v36, v26, v92 row_newbcast:7 row_mask:0xf bank_mask:0xf
    v_fmac_f32_dpp v37, v26, v93 row_newbcast:7 row_mask:0xf bank_mask:0xf
    v_fmac_f32_dpp v38, v26, v94 row_newbcast:7 row_mask:0xf bank_mask:0xf
    v_fmac_f32_dpp v39, v26, v95 row_newbcast:7 row_mask:0xf bank_mask:0xf
    v_permlane32_swap_b32 v24, v25
    v_fmac_f32_dpp v32, v26, v96 row_newbcast:8 row_mask:0xf bank_mask:0xf
    v_fmac_f32_dpp v33, v26, v97 row_newbcast:8 row_mask:0xf bank_mask:0xf
    v_fmac_f32_dpp v34, v26, v98 row_newbcast:8 row_mask:0xf bank_mask:0xf
    v_fmac_f32_dpp v35, v26, v99 row_newbcast:8 row_mask:0xf bank_mask:0xf
    v_add_f32 v24, v24, v25
    v_fmac_f32_dpp v36, v26, v100 row_newbcast:9 row_mask:0xf bank_mask:0xf
    v_fmac_f32_dpp v37, v26, v101 row_newbcast:9 row_mask:0xf bank_mask:0xf
    v_fmac_f32_dpp v38, v26, v102 row_newbcast:9 row_mask:0xf bank_mask:0xf
    v_fmac_f32_dpp v39, v26, v103 row_newbcast:9 row_mask:0xf bank_mask:0xf
    v_rcp_f32 v24, v24
    v_fmac_f32_dpp v32, v26, v104 row_newbcast:10 row_mask:0xf bank_mask:0xf
    v_fmac_f32_dpp v33, v26, v105 row_newbcast:10 row_mask:0xf bank_mask:0xf
    v_fmac_f32_dpp v34, v26, v106 row_newbcast:10 row_mask:0xf bank_mask:0xf
    v_fmac_f32_dpp v35, v26, v107 row_newbcast:10 row_mask:0xf bank_mask:0xf
    v_fmac_f32_dpp v36, v26, v108 row_newbcast:11 row_mask:0xf bank_mask:0xf
    v_fmac_f32_dpp v37, v26, v109 row_newbcast:11 row_mask:0xf bank_mask:0xf
    v_fmac_f32_dpp v38, v26, v110 row_newbcast:11 row_mask:0xf bank_mask:0xf
    v_fmac_f32_dpp v39, v26, v111 row_newbcast:11 row_mask:0xf bank_mask:0xf
    v_fmac_f32_dpp v32, v26, v112 row_newbcast:12 row_mask:0xf bank_mask:0xf
    v_fmac_f32_dpp v33, v26, v113 row_newbcast:12 row_mask:0xf bank_mask:0xf
    v_fmac_f32_dpp v34, v26, v114 row_newbcast:12 row_mask:0xf bank_mask:0xf
    v_fmac_f32_dpp v35, v26, v115 row_newbcast:12 row_mask:0xf bank_mask:0xf
    v_fmac_f32_dpp v36, v26, v116 row_newbcast:13 row_mask:0xf bank_mask:0xf
    v_fmac_f32_dpp v37, v26, v117 row_newbcast:13 row_mask:0xf bank_mask:0xf
    v_fmac_f32_dpp v38, v26, v118 row_newbcast:13 row_mask:0xf bank_mask:0xf
    v_fmac_f32_dpp v39, v26, v119 row_newbcast:13 row_mask:0xf bank_mask:0xf
    v_fmac_f32_dpp v32, v26, v120 row_newbcast:14 row_mask:0xf bank_mask:0xf
    v_fmac_f32_dpp v33, v26, v121 row_newbcast:14 row_mask:0xf bank_mask:0xf
    v_fmac_f32_dpp v34, v26, v122 row_newbcast:14 row_mask:0xf bank_mask:0xf
    v_fmac_f32_dpp v35, v26, v123 row_newbcast:14 row_mask:0xf bank_mask:0xf
    v_fmac_f32_dpp v36, v26, v124 row_newbcast:15 row_mask:0xf bank_mask:0xf
    v_fmac_f32_dpp v37, v26, v125 row_newbcast:15 row_mask:0xf bank_mask:0xf
    v_fmac_f32_dpp v38, v26, v126 row_newbcast:15 row_mask:0xf bank_mask:0xf
    v_fmac_f32_dpp v39, v26, v127 row_newbcast:15 row_mask:0xf bank_mask:0xf
    v_add_f32 v32, v32, v36
    v_add_f32 v33, v33, v37
    v_add_f32 v34, v34, v38
    v_add_f32 v35, v35, v39
    s_nop 0
    v_permlane32_swap_b32 v32, v34
    v_permlane32_swap_b32 v33, v35
    v_add_f32 v32, v32, v34
    v_add_f32 v33, v33, v35
    v_mul_f32 v32, v32, v24
    v_mul_f32 v33, v33, v24
    v_cvt_pk_bf16_f32 v32, v32, v33
    ds_write_b32 v23, v32 offset:13824
    ds_read_b128 v[192:195], v16 offset:13824
    ds_read_b128 v[196:199], v16 offset:13952
    s_waitcnt lgkmcnt(1)
    v_mfma_f32_16x16x32_bf16 v[32:35], v[128:131], v[192:195], 0
    v_mfma_f32_16x16x32_bf16 v[36:39], v[132:135], v[192:195], 0
    v_mfma_f32_16x16x32_bf16 v[40:43], v[136:139], v[192:195], 0
    v_mfma_f32_16x16x32_bf16 v[44:47], v[140:143], v[192:195], 0
    v_mfma_f32_16x16x32_bf16 v[48:51], v[144:147], v[192:195], 0
    v_mfma_f32_16x16x32_bf16 v[52:55], v[148:151], v[192:195], 0
    v_mfma_f32_16x16x32_bf16 v[56:59], v[152:155], v[192:195], 0
    v_mfma_f32_16x16x32_bf16 v[60:63], v[156:159], v[192:195], 0
    s_waitcnt lgkmcnt(0)
    v_mfma_f32_16x16x32_bf16 v[32:35], v[160:163], v[196:199], v[32:35]
    v_mfma_f32_16x16x32_bf16 v[36:39], v[164:167], v[196:199], v[36:39]
    v_mfma_f32_16x16x32_bf16 v[40:43], v[168:171], v[196:199], v[40:43]
    v_mfma_f32_16x16x32_bf16 v[44:47], v[172:175], v[196:199], v[44:47]
    v_mfma_f32_16x16x32_bf16 v[48:51], v[176:179], v[196:199], v[48:51]
    v_mfma_f32_16x16x32_bf16 v[52:55], v[180:183], v[196:199], v[52:55]
    v_mfma_f32_16x16x32_bf16 v[56:59], v[184:187], v[196:199], v[56:59]
    v_mfma_f32_16x16x32_bf16 v[60:63], v[188:191], v[196:199], v[60:63]
    s_and_b32 exec_lo, s60, 0x10001
    s_and_b32 exec_hi, s61, 0x20002
    ds_write_b128 v17, v[32:35] offset:14848
    ds_write_b128 v17, v[36:39] offset:14880
    ds_write_b128 v17, v[40:43] offset:14912
    ds_write_b128 v17, v[44:47] offset:14944
    ds_write_b128 v17, v[48:51] offset:14976
    ds_write_b128 v17, v[52:55] offset:15008
    ds_write_b128 v17, v[56:59] offset:15040
    ds_write_b128 v17, v[60:63] offset:15072
    s_and_b64 exec, s[60:61], 1
    ds_add_rtn_u32 v19, v10, v19 offset:52
    s_mov_b64 exec, s[60:61]
    ds_read_b128 v[192:195], v18 offset:14848
    ds_read_b128 v[196:199], v18 offset:15104
    s_waitcnt lgkmcnt(2)
    v_readfirstlane_b32 s30, v19
    s_cbranch_execz L_t2b
    s_cmp_lg_u32 s30, 3
    s_cbranch_scc1 L_exit
L_t2b:
    s_waitcnt lgkmcnt(0)
    v_add_f32 v192, v192, v196
    v_add_f32 v193, v193, v197
    v_add_f32 v194, v194, v198
    v_add_f32 v195, v195, v199
    v_mov_b32 v196, v192
    v_mov_b32 v197, v193
    v_mov_b32 v198, v194
    v_mov_b32 v199, v195
    v_permlane32_swap_b32 v192, v196
    v_permlane32_swap_b32 v193, v197
    v_permlane32_swap_b32 v194, v198
    v_permlane32_swap_b32 v195, v199
    v_add_f32 v192, v192, v196
    v_add_f32 v193, v193, v197
    v_add_f32 v194, v194, v198
    v_add_f32 v195, v195, v199
    v_mov_b32 v196, v192
    v_mov_b32 v197, v193
    v_mov_b32 v198, v194
    v_mov_b32 v199, v195
    v_permlane16_swap_b32 v192, v196
    v_permlane16_swap_b32 v193, v197
    v_permlane16_swap_b32 v194, v198
    v_permlane16_swap_b32 v195, v199
    v_add_f32 v192, v192, v196
    v_add_f32 v193, v193, v197
    v_add_f32 v194, v194, v198
    v_add_f32 v195, v195, v199
    v_bfi_b32 v192, s76, v4, v192
    v_bfi_b32 v193, s76, v5, v193
    v_bfi_b32 v194, s76, v6, v194
    v_bfi_b32 v195, s76, v7, v195
    s_and_b32 exec_lo, s60, 0xffff
    s_and_b32 exec_hi, s61, 0x0
    s_cbranch_execz L_t3
    buffer_store_dwordx4 v[192:195], v1, s[12:15], s97 offen sc1
    s_branch L_exit
L_h0:
    v_lshrrev_b32 v20, 4, v0
    v_lshlrev_b32 v20, 22, v20
    v_and_b32 v21, 15, v0
    v_lshl_add_u32 v20, v21, 13, v20
    s_lshl_b32 s30, s25, 17
    v_add_u32 v20, s30, v20
    v_cmp_gt_u32 vcc, 52, v0
    v_mov_b32 v28, -1
    s_nop 0
    v_cndmask_b32 v20, v28, v20, vcc
    v_lshlrev_b32 v21, 2, v0
    ds_write_b32 v21, v20 offset:1536
    ds_write_b32 v21, v28 offset:1792
    s_mov_b64 exec, 0xff
    ds_write_b32 v21, v10 offset:32
    s_mov_b64 exec, -1
    s_cmp_lg_u32 s25, 0
    s_cbranch_scc1 L_h0c
    v_mov_b32 v21, 1664
    v_lshlrev_b32 v20, 8, v0
    s_lshl_b32 s30, s24, 10
    s_add_u32 s30, s30, 4096
    s_mov_b64 exec, 15
    buffer_store_dword v21, v20, s[12:15], s30 offen sc1
    s_mov_b64 exec, -1
L_h0c:
    s_waitcnt vmcnt(16)
    v_lshlrev_b32 v28, 16, v24
    v_and_b32 v29, 0xffff0000, v24
    v_lshlrev_b32 v30, 16, v25
    v_and_b32 v31, 0xffff0000, v25
    v_lshlrev_b32 v32, 16, v26
    v_and_b32 v33, 0xffff0000, v26
    v_lshlrev_b32 v34, 16, v27
    v_and_b32 v35, 0xffff0000, v27
    v_add_u32 v9, 0x01010101, v9
    v_readfirstlane_b32 s30, v28
    s_nop 1
    v_subrev_f32 v40, s30, v28
    v_subrev_f32 v41, s30, v29
    v_subrev_f32 v42, s30, v30
    v_subrev_f32 v43, s30, v31
    v_subrev_f32 v44, s30, v32
    v_subrev_f32 v45, s30, v33
    v_subrev_f32 v46, s30, v34
    v_subrev_f32 v47, s30, v35
    v_add_f32 v48, v40, v41
    v_mul_f32 v49, v40, v40
    v_add_f32 v50, v42, v43
    v_mul_f32 v51, v41, v41
    v_add_f32 v48, v48, v44
    v_fmac_f32 v49, v42, v42
    v_add_f32 v50, v50, v45
    v_fmac_f32 v51, v43, v43
    v_add_f32 v48, v48, v46
    v_fmac_f32 v49, v44, v44
    v_add_f32 v50, v50, v47
    v_fmac_f32 v51, v45, v45
    v_fmac_f32 v49, v46, v46
    v_fmac_f32 v51, v47, v47
    v_add_f32 v48, v48, v50
    v_add_f32 v49, v49, v51
    s_nop 1
    v_permlane32_swap_b32 v48, v49
    v_add_f32 v48, v48, v49
    s_nop 1
    v_add_f32_dpp v48, v48, v48 row_ror:8 row_mask:0xf bank_mask:0xf
    s_nop 1
    v_add_f32_dpp v48, v48, v48 row_ror:4 row_mask:0xf bank_mask:0xf
    s_nop 1
    v_add_f32_dpp v48, v48, v48 row_ror:2 row_mask:0xf bank_mask:0xf
    s_nop 1
    v_add_f32_dpp v48, v48, v48 row_ror:1 row_mask:0xf bank_mask:0xf
    s_nop 0
    v_readlane_b32 s31, v48, 0
    v_readlane_b32 s89, v48, 16
    v_readlane_b32 s90, v48, 32
    v_readlane_b32 s91, v48, 48
    v_mov_b32 v40, s31
    v_mov_b32 v41, s90
    v_add_f32 v40, s89, v40
    v_add_f32 v41, s91, v41
    v_mul_f32 v40, 0x3b000000, v40
    v_mul_f32 v41, 0x3b000000, v41
    v_fma_f32 v41, -v40, v40, v41
    v_add_f32 v40, s30, v40
    v_max_f32 v41, 0, v41
    v_cvt_pk_bf16_f32 v41, 0, v41
    v_cvt_pk_bf16_f32 v40, 0, v40
    v_add_f32 v41, 0x3727c5ac, v41
    v_cvt_pk_bf16_f32 v41, 0, v41
    v_sqrt_f32 v41, v41
    v_sub_f32 v28, v28, v40
    v_sub_f32 v29, v29, v40
    v_sub_f32 v30, v30, v40
    v_sub_f32 v31, v31, v40
    v_sub_f32 v32, v32, v40
    v_sub_f32 v33, v33, v40
    v_sub_f32 v34, v34, v40
    v_sub_f32 v35, v35, v40
    v_cvt_pk_bf16_f32 v41, 0, v41
    v_rcp_f32 v42, v41
    v_cvt_pk_bf16_f32 v28, 0, v28
    v_cvt_pk_bf16_f32 v29, 0, v29
    v_cvt_pk_bf16_f32 v30, 0, v30
    v_cvt_pk_bf16_f32 v31, 0, v31
    v_cvt_pk_bf16_f32 v32, 0, v32
    v_cvt_pk_bf16_f32 v33, 0, v33
    v_cvt_pk_bf16_f32 v34, 0, v34
    v_cvt_pk_bf16_f32 v35, 0, v35
    v_mul_f32 v43, v28, v42
    v_mul_f32 v44, v29, v42
    v_mul_f32 v45, v30, v42
    v_mul_f32 v46, v31, v42
    v_mul_f32 v47, v32, v42
    v_mul_f32 v48, v33, v42
    v_mul_f32 v49, v34, v42
    v_mul_f32 v50, v35, v42
    v_fma_f32 v28, -v43, v41, v28
    v_fma_f32 v29, -v44, v41, v29
    v_fma_f32 v30, -v45, v41, v30
    v_fma_f32 v31, -v46, v41, v31
    v_fma_f32 v32, -v47, v41, v32
    v_fma_f32 v33, -v48, v41, v33
    v_fma_f32 v34, -v49, v41, v34
    v_fma_f32 v35, -v50, v41, v35
    v_fmac_f32 v43, v28, v42
    v_fmac_f32 v44, v29, v42
    v_fmac_f32 v45, v30, v42
    v_fmac_f32 v46, v31, v42
    v_fmac_f32 v47, v32, v42
    v_fmac_f32 v48, v33, v42
    v_fmac_f32 v49, v34, v42
    v_fmac_f32 v50, v35, v42
    v_cvt_pk_bf16_f32 v28, 0, v43
    v_cvt_pk_bf16_f32 v29, 0, v44
    v_cvt_pk_bf16_f32 v30, 0, v45
    v_cvt_pk_bf16_f32 v31, 0, v46
    v_cvt_pk_bf16_f32 v32, 0, v47
    v_cvt_pk_bf16_f32 v33, 0, v48
    v_cvt_pk_bf16_f32 v34, 0, v49
    v_cvt_pk_bf16_f32 v35, 0, v50
    v_perm_b32 v36, v29, v28, s78
    v_perm_b32 v37, v31, v30, s78
    v_perm_b32 v38, v33, v32, s78
    v_perm_b32 v39, v35, v34, s78
    v_mov_b32 v4, v9
    v_lshrrev_b32 v5, 8, v4
    v_lshrrev_b32 v6, 16, v4
    v_lshrrev_b32 v7, 24, v4
    v_mov_b32 v40, 0
    v_mov_b32 v41, 0
    v_mov_b32 v42, 0
    v_mov_b32 v43, 0
    v_mov_b32 v44, 0
    v_mov_b32 v45, 0
    v_mov_b32 v46, 0
    v_mov_b32 v47, 0
L_h0a0:
    s_waitcnt vmcnt(14)
    v_perm_b32 v48, v68, v64, s77
    v_perm_b32 v49, v68, v64, s78
    v_perm_b32 v50, v69, v65, s77
    v_perm_b32 v51, v69, v65, s78
    v_perm_b32 v52, v70, v66, s77
    v_perm_b32 v53, v70, v66, s78
    v_perm_b32 v54, v71, v67, s77
    v_perm_b32 v55, v71, v67, s78
    v_dot2c_f32_bf16_dpp v40, v36, v48 quad_perm:[0,0,2,2] row_mask:0xf bank_mask:0xf
    v_dot2c_f32_bf16_dpp v41, v36, v49 quad_perm:[0,0,2,2] row_mask:0xf bank_mask:0xf
    v_dot2c_f32_bf16_dpp v42, v36, v50 quad_perm:[0,0,2,2] row_mask:0xf bank_mask:0xf
    v_dot2c_f32_bf16_dpp v43, v36, v51 quad_perm:[0,0,2,2] row_mask:0xf bank_mask:0xf
    v_dot2c_f32_bf16_dpp v44, v36, v52 quad_perm:[0,0,2,2] row_mask:0xf bank_mask:0xf
    v_dot2c_f32_bf16_dpp v45, v36, v53 quad_perm:[0,0,2,2] row_mask:0xf bank_mask:0xf
    v_dot2c_f32_bf16_dpp v46, v36, v54 quad_perm:[0,0,2,2] row_mask:0xf bank_mask:0xf
    v_dot2c_f32_bf16_dpp v47, v36, v55 quad_perm:[0,0,2,2] row_mask:0xf bank_mask:0xf
L_h0a1:
    s_waitcnt vmcnt(12)
    v_perm_b32 v48, v76, v72, s77
    v_perm_b32 v49, v76, v72, s78
    v_perm_b32 v50, v77, v73, s77
    v_perm_b32 v51, v77, v73, s78
    v_perm_b32 v52, v78, v74, s77
    v_perm_b32 v53, v78, v74, s78
    v_perm_b32 v54, v79, v75, s77
    v_perm_b32 v55, v79, v75, s78
    v_dot2c_f32_bf16_dpp v40, v37, v48 quad_perm:[0,0,2,2] row_mask:0xf bank_mask:0xf
    v_dot2c_f32_bf16_dpp v41, v37, v49 quad_perm:[0,0,2,2] row_mask:0xf bank_mask:0xf
    v_dot2c_f32_bf16_dpp v42, v37, v50 quad_perm:[0,0,2,2] row_mask:0xf bank_mask:0xf
    v_dot2c_f32_bf16_dpp v43, v37, v51 quad_perm:[0,0,2,2] row_mask:0xf bank_mask:0xf
    v_dot2c_f32_bf16_dpp v44, v37, v52 quad_perm:[0,0,2,2] row_mask:0xf bank_mask:0xf
    v_dot2c_f32_bf16_dpp v45, v37, v53 quad_perm:[0,0,2,2] row_mask:0xf bank_mask:0xf
    v_dot2c_f32_bf16_dpp v46, v37, v54 quad_perm:[0,0,2,2] row_mask:0xf bank_mask:0xf
    v_dot2c_f32_bf16_dpp v47, v37, v55 quad_perm:[0,0,2,2] row_mask:0xf bank_mask:0xf
L_h0a2:
    s_waitcnt vmcnt(10)
    v_perm_b32 v48, v84, v80, s77
    v_perm_b32 v49, v84, v80, s78
    v_perm_b32 v50, v85, v81, s77
    v_perm_b32 v51, v85, v81, s78
    v_perm_b32 v52, v86, v82, s77
    v_perm_b32 v53, v86, v82, s78
    v_perm_b32 v54, v87, v83, s77
    v_perm_b32 v55, v87, v83, s78
    v_dot2c_f32_bf16_dpp v40, v38, v48 quad_perm:[0,0,2,2] row_mask:0xf bank_mask:0xf
    v_dot2c_f32_bf16_dpp v41, v38, v49 quad_perm:[0,0,2,2] row_mask:0xf bank_mask:0xf
    v_dot2c_f32_bf16_dpp v42, v38, v50 quad_perm:[0,0,2,2] row_mask:0xf bank_mask:0xf
    v_dot2c_f32_bf16_dpp v43, v38, v51 quad_perm:[0,0,2,2] row_mask:0xf bank_mask:0xf
    v_dot2c_f32_bf16_dpp v44, v38, v52 quad_perm:[0,0,2,2] row_mask:0xf bank_mask:0xf
    v_dot2c_f32_bf16_dpp v45, v38, v53 quad_perm:[0,0,2,2] row_mask:0xf bank_mask:0xf
    v_dot2c_f32_bf16_dpp v46, v38, v54 quad_perm:[0,0,2,2] row_mask:0xf bank_mask:0xf
    v_dot2c_f32_bf16_dpp v47, v38, v55 quad_perm:[0,0,2,2] row_mask:0xf bank_mask:0xf
L_h0a3:
    s_waitcnt vmcnt(8)
    v_perm_b32 v48, v92, v88, s77
    v_perm_b32 v49, v92, v88, s78
    v_perm_b32 v50, v93, v89, s77
    v_perm_b32 v51, v93, v89, s78
    v_perm_b32 v52, v94, v90, s77
    v_perm_b32 v53, v94, v90, s78
    v_perm_b32 v54, v95, v91, s77
    v_perm_b32 v55, v95, v91, s78
    v_dot2c_f32_bf16_dpp v40, v39, v48 quad_perm:[0,0,2,2] row_mask:0xf bank_mask:0xf
    v_dot2c_f32_bf16_dpp v41, v39, v49 quad_perm:[0,0,2,2] row_mask:0xf bank_mask:0xf
    v_dot2c_f32_bf16_dpp v42, v39, v50 quad_perm:[0,0,2,2] row_mask:0xf bank_mask:0xf
    v_dot2c_f32_bf16_dpp v43, v39, v51 quad_perm:[0,0,2,2] row_mask:0xf bank_mask:0xf
    v_dot2c_f32_bf16_dpp v44, v39, v52 quad_perm:[0,0,2,2] row_mask:0xf bank_mask:0xf
    v_dot2c_f32_bf16_dpp v45, v39, v53 quad_perm:[0,0,2,2] row_mask:0xf bank_mask:0xf
    v_dot2c_f32_bf16_dpp v46, v39, v54 quad_perm:[0,0,2,2] row_mask:0xf bank_mask:0xf
    v_dot2c_f32_bf16_dpp v47, v39, v55 quad_perm:[0,0,2,2] row_mask:0xf bank_mask:0xf
L_h0a4:
    s_waitcnt vmcnt(6)
    v_perm_b32 v48, v100, v96, s77
    v_perm_b32 v49, v100, v96, s78
    v_perm_b32 v50, v101, v97, s77
    v_perm_b32 v51, v101, v97, s78
    v_perm_b32 v52, v102, v98, s77
    v_perm_b32 v53, v102, v98, s78
    v_perm_b32 v54, v103, v99, s77
    v_perm_b32 v55, v103, v99, s78
    v_dot2c_f32_bf16_dpp v40, v36, v48 quad_perm:[1,1,3,3] row_mask:0xf bank_mask:0xf
    v_dot2c_f32_bf16_dpp v41, v36, v49 quad_perm:[1,1,3,3] row_mask:0xf bank_mask:0xf
    v_dot2c_f32_bf16_dpp v42, v36, v50 quad_perm:[1,1,3,3] row_mask:0xf bank_mask:0xf
    v_dot2c_f32_bf16_dpp v43, v36, v51 quad_perm:[1,1,3,3] row_mask:0xf bank_mask:0xf
    v_dot2c_f32_bf16_dpp v44, v36, v52 quad_perm:[1,1,3,3] row_mask:0xf bank_mask:0xf
    v_dot2c_f32_bf16_dpp v45, v36, v53 quad_perm:[1,1,3,3] row_mask:0xf bank_mask:0xf
    v_dot2c_f32_bf16_dpp v46, v36, v54 quad_perm:[1,1,3,3] row_mask:0xf bank_mask:0xf
    v_dot2c_f32_bf16_dpp v47, v36, v55 quad_perm:[1,1,3,3] row_mask:0xf bank_mask:0xf
L_h0a5:
    s_waitcnt vmcnt(4)
    v_perm_b32 v48, v108, v104, s77
    v_perm_b32 v49, v108, v104, s78
    v_perm_b32 v50, v109, v105, s77
    v_perm_b32 v51, v109, v105, s78
    v_perm_b32 v52, v110, v106, s77
    v_perm_b32 v53, v110, v106, s78
    v_perm_b32 v54, v111, v107, s77
    v_perm_b32 v55, v111, v107, s78
    v_dot2c_f32_bf16_dpp v40, v37, v48 quad_perm:[1,1,3,3] row_mask:0xf bank_mask:0xf
    v_dot2c_f32_bf16_dpp v41, v37, v49 quad_perm:[1,1,3,3] row_mask:0xf bank_mask:0xf
    v_dot2c_f32_bf16_dpp v42, v37, v50 quad_perm:[1,1,3,3] row_mask:0xf bank_mask:0xf
    v_dot2c_f32_bf16_dpp v43, v37, v51 quad_perm:[1,1,3,3] row_mask:0xf bank_mask:0xf
    v_dot2c_f32_bf16_dpp v44, v37, v52 quad_perm:[1,1,3,3] row_mask:0xf bank_mask:0xf
    v_dot2c_f32_bf16_dpp v45, v37, v53 quad_perm:[1,1,3,3] row_mask:0xf bank_mask:0xf
    v_dot2c_f32_bf16_dpp v46, v37, v54 quad_perm:[1,1,3,3] row_mask:0xf bank_mask:0xf
    v_dot2c_f32_bf16_dpp v47, v37, v55 quad_perm:[1,1,3,3] row_mask:0xf bank_mask:0xf
L_h0a6:
    s_waitcnt vmcnt(2)
    v_perm_b32 v48, v116, v112, s77
    v_perm_b32 v49, v116, v112, s78
    v_perm_b32 v50, v117, v113, s77
    v_perm_b32 v51, v117, v113, s78
    v_perm_b32 v52, v118, v114, s77
    v_perm_b32 v53, v118, v114, s78
    v_perm_b32 v54, v119, v115, s77
    v_perm_b32 v55, v119, v115, s78
    v_dot2c_f32_bf16_dpp v40, v38, v48 quad_perm:[1,1,3,3] row_mask:0xf bank_mask:0xf
    v_dot2c_f32_bf16_dpp v41, v38, v49 quad_perm:[1,1,3,3] row_mask:0xf bank_mask:0xf
    v_dot2c_f32_bf16_dpp v42, v38, v50 quad_perm:[1,1,3,3] row_mask:0xf bank_mask:0xf
    v_dot2c_f32_bf16_dpp v43, v38, v51 quad_perm:[1,1,3,3] row_mask:0xf bank_mask:0xf
    v_dot2c_f32_bf16_dpp v44, v38, v52 quad_perm:[1,1,3,3] row_mask:0xf bank_mask:0xf
    v_dot2c_f32_bf16_dpp v45, v38, v53 quad_perm:[1,1,3,3] row_mask:0xf bank_mask:0xf
    v_dot2c_f32_bf16_dpp v46, v38, v54 quad_perm:[1,1,3,3] row_mask:0xf bank_mask:0xf
    v_dot2c_f32_bf16_dpp v47, v38, v55 quad_perm:[1,1,3,3] row_mask:0xf bank_mask:0xf
L_h0a7:
    s_waitcnt vmcnt(0)
    v_perm_b32 v48, v124, v120, s77
    v_perm_b32 v49, v124, v120, s78
    v_perm_b32 v50, v125, v121, s77
    v_perm_b32 v51, v125, v121, s78
    v_perm_b32 v52, v126, v122, s77
    v_perm_b32 v53, v126, v122, s78
    v_perm_b32 v54, v127, v123, s77
    v_perm_b32 v55, v127, v123, s78
    v_dot2c_f32_bf16_dpp v40, v39, v48 quad_perm:[1,1,3,3] row_mask:0xf bank_mask:0xf
    v_dot2c_f32_bf16_dpp v41, v39, v49 quad_perm:[1,1,3,3] row_mask:0xf bank_mask:0xf
    v_dot2c_f32_bf16_dpp v42, v39, v50 quad_perm:[1,1,3,3] row_mask:0xf bank_mask:0xf
    v_dot2c_f32_bf16_dpp v43, v39, v51 quad_perm:[1,1,3,3] row_mask:0xf bank_mask:0xf
    v_dot2c_f32_bf16_dpp v44, v39, v52 quad_perm:[1,1,3,3] row_mask:0xf bank_mask:0xf
    v_dot2c_f32_bf16_dpp v45, v39, v53 quad_perm:[1,1,3,3] row_mask:0xf bank_mask:0xf
    v_dot2c_f32_bf16_dpp v46, v39, v54 quad_perm:[1,1,3,3] row_mask:0xf bank_mask:0xf
    v_dot2c_f32_bf16_dpp v47, v39, v55 quad_perm:[1,1,3,3] row_mask:0xf bank_mask:0xf
    v_permlane32_swap_b32 v40, v44
    v_permlane32_swap_b32 v41, v45
    v_permlane32_swap_b32 v42, v46
    v_permlane32_swap_b32 v43, v47
    v_add_f32 v40, v40, v44
    v_add_f32 v41, v41, v45
    v_add_f32 v42, v42, v46
    v_add_f32 v43, v43, v47
    v_mov_b32 v44, v40
    v_mov_b32 v45, v41
    v_mov_b32 v46, v42
    v_mov_b32 v47, v43
    v_permlane16_swap_b32 v40, v44
    v_permlane16_swap_b32 v41, v45
    v_permlane16_swap_b32 v42, v46
    v_permlane16_swap_b32 v43, v47
    v_add_f32 v40, v40, v44
    v_add_f32 v41, v41, v45
    v_add_f32 v42, v42, v46
    v_add_f32 v43, v43, v47
    v_add_f32_dpp v40, v40, v40 row_ror:8 row_mask:0xf bank_mask:0xf
    v_add_f32_dpp v41, v41, v41 row_ror:8 row_mask:0xf bank_mask:0xf
    v_add_f32_dpp v42, v42, v42 row_ror:8 row_mask:0xf bank_mask:0xf
    v_add_f32_dpp v43, v43, v43 row_ror:8 row_mask:0xf bank_mask:0xf
    v_add_f32_dpp v40, v40, v40 row_ror:4 row_mask:0xf bank_mask:0xf
    v_add_f32_dpp v41, v41, v41 row_ror:4 row_mask:0xf bank_mask:0xf
    v_add_f32_dpp v42, v42, v42 row_ror:4 row_mask:0xf bank_mask:0xf
    v_add_f32_dpp v43, v43, v43 row_ror:4 row_mask:0xf bank_mask:0xf
    v_add_f32_dpp v40, v40, v40 row_ror:2 row_mask:0xf bank_mask:0xf
    v_add_f32_dpp v41, v41, v41 row_ror:2 row_mask:0xf bank_mask:0xf
    v_add_f32_dpp v42, v42, v42 row_ror:2 row_mask:0xf bank_mask:0xf
    v_add_f32_dpp v43, v43, v43 row_ror:2 row_mask:0xf bank_mask:0xf
    v_cvt_pk_bf16_f32 v40, 0, v40
    v_cvt_pk_bf16_f32 v41, 0, v41
    v_cvt_pk_bf16_f32 v42, 0, v42
    v_cvt_pk_bf16_f32 v43, 0, v43
    v_bfi_b32 v40, s76, v4, v40
    v_bfi_b32 v41, s76, v5, v41
    v_bfi_b32 v42, s76, v6, v42
    v_bfi_b32 v43, s76, v7, v43
    v_lshlrev_b32 v20, 5, v23
    v_lshrrev_b32 v21, 5, v0
    v_lshl_add_u32 v20, v21, 4, v20
    s_lshl_b32 s92, s24, 11
    s_add_u32 s92, s92, 65536
    s_lshl_b32 s30, s93, 6
    s_add_u32 s30, s30, s92
    s_and_b32 exec_lo, s60, 3
    s_and_b32 exec_hi, s61, 3
    s_cbranch_execz L_qst
    buffer_store_dwordx4 v[40:43], v20, s[12:15], s30 offen sc1
L_qst:
    s_mov_b64 exec, s[60:61]
    v_mov_b32 v21, 1
    ds_write_b32 v10, v9 offset:16
    ds_write_b32 v10, v21 offset:4
    v_bfe_u32 v20, v0, 2, 2
    v_lshlrev_b32 v20, 9, v20
    v_lshrrev_b32 v21, 4, v0
    v_lshl_add_u32 v20, v21, 7, v20
    v_and_b32 v21, 3, v0
    v_lshl_add_u32 v20, v21, 5, v20
    s_mov_b64 s[64:65], s[60:61]
    s_mov_b32 s63, 1000000
Lg_35:
    s_mov_b64 exec, s[64:65]
    s_cbranch_execz Ls_37
    buffer_load_dwordx4 v[48:51], v20, s[12:15], s92 offen offset:0 sc1
    buffer_load_dwordx4 v[52:55], v20, s[12:15], s92 offen offset:16 sc1
Ls_37:
    s_mov_b64 s[86:87], 0
    s_waitcnt vmcnt(0)
    s_mov_b64 exec, s[64:65]
    s_cbranch_execz Ls_38
    v_xor_b32 v21, v48, v4
    v_bitop3_b32 v21, v21, v49, v5 bitop3:0xf6
    v_bitop3_b32 v21, v21, v50, v6 bitop3:0xf6
    v_bitop3_b32 v21, v21, v51, v7 bitop3:0xf6
    v_bitop3_b32 v21, v21, v52, v4 bitop3:0xf6
    v_bitop3_b32 v21, v21, v53, v5 bitop3:0xf6
    v_bitop3_b32 v21, v21, v54, v6 bitop3:0xf6
    v_bitop3_b32 v21, v21, v55, v7 bitop3:0xf6
    v_and_b32 v21, 0xff, v21
    v_cmp_ne_u32 s[64:65], 0, v21
    s_or_b64 s[86:87], s[86:87], s[64:65]
Ls_38:
    s_cmp_eq_u64 s[86:87], 0
    s_cbranch_scc1 Lgd_36
    s_sub_u32 s63, s63, 1
    s_cmp_lg_u32 s63, 0
    s_cbranch_scc1 Lg_35
Lgd_36:
    s_mov_b64 exec, s[60:61]
    v_perm_b32 v56, v49, v48, s78
    v_perm_b32 v57, v51, v50, s78
    v_perm_b32 v58, v53, v52, s78
    v_perm_b32 v59, v55, v54, s78
    ds_write_b128 v2, v[56:59] offset:256
    ds_write_b32 v10, v9 offset:16
    v_mov_b32 v21, 1
    s_waitcnt lgkmcnt(0)
    ds_write_b32 v10, v21 offset:0
    s_setprio 0
    s_cbranch_execnz L_hk
L_h123:
    s_cbranch_execz L_dryret
    v_mov_b32 v9, 0
    s_mov_b32 s29, 0
    s_mov_b32 s81, 0
    s_mov_b32 s83, 0
    s_mov_b64 s[84:85], 0
    s_mov_b64 s[60:61], 0
    s_mov_b64 exec, 0
    s_cmp_eq_u32 s3, 3
    s_cbranch_scc1 L_h0c
    s_cmp_eq_u32 s3, 2
    s_cbranch_scc1 L_loop
    s_branch L_stream
L_dryret:
    s_mov_b64 s[60:61], -1
    s_mov_b64 exec, -1
    s_mov_b32 s63, 2000000
Lq_39:
    ds_read_b32 v20, v10 offset:0
    s_waitcnt lgkmcnt(0)
    v_readfirstlane_b32 s30, v20
    s_cmp_lg_u32 s30, 0
    s_cbranch_scc1 Lqd_40
    s_sleep 8
    s_sub_u32 s63, s63, 1
    s_cmp_lg_u32 s63, 0
    s_cbranch_scc1 Lq_39
Lqd_40:
    ds_read_b32 v9, v10 offset:16
L_hk:
    s_load_dwordx16 s[32:47], s[0:1], 0
    s_load_dwordx8 s[48:55], s[0:1], 64
    s_waitcnt lgkmcnt(0)
    v_mov_b32 v4, v9
    v_lshrrev_b32 v5, 8, v4
    v_lshrrev_b32 v6, 16, v4
    v_lshrrev_b32 v7, 24, v4
    s_and_b32 s30, s24, 1
    s_lshl_b32 s30, s30, 2
    s_sub_u32 s30, s25, s30
    s_lshl_b32 s88, s24, 2
    s_add_u32 s88, s88, s30
    s_cmp_lt_u32 s30, 4
    s_cselect_b32 s88, s88, 99
    v_bfe_u32 v20, v0, 4, 1
    v_lshlrev_b32 v20, 6, v20
    v_bfe_u32 v21, v0, 3, 1
    v_lshl_add_u32 v20, v21, 1, v20
    v_lshrrev_b32 v21, 5, v0
    v_add_u32 v20, v20, v21
    v_and_b32 v21, 7, v0
    v_lshlrev_b32 v21, 4, v21
    s_waitcnt vmcnt(0)
    s_cmp_lt_u32 s25, 24
    s_cbranch_scc1 L_hw
    s_and_b32 s30, s25, 7
    s_add_u32 s25, s24, 24
    s_mov_b32 s24, s30
    s_mov_b32 s16, s40
    s_mov_b32 s17, s41
    s_mov_b32 s18, 4194304
    s_mov_b32 s19, 0x20000
    v_lshl_add_u32 v20, v20, 10, v21
    s_lshl_b32 s30, s24, 2
    s_add_u32 s30, s30, s3
    s_lshl_b32 s30, s30, 17
    s_and_b32 s31, s25, 7
    s_lshl_b32 s31, s31, 7
    s_add_u32 s30, s30, s31
    s_add_u32 s31, s30, 0
    buffer_load_dwordx4 v[64:67], v20, s[16:19], s31 offen nt
    s_add_u32 s31, s30, 8192
    buffer_load_dwordx4 v[68:71], v20, s[16:19], s31 offen nt
    s_add_u32 s31, s30, 16384
    buffer_load_dwordx4 v[72:75], v20, s[16:19], s31 offen nt
    s_add_u32 s31, s30, 24576
    buffer_load_dwordx4 v[76:79], v20, s[16:19], s31 offen nt
    s_add_u32 s31, s30, 32768
    buffer_load_dwordx4 v[80:83], v20, s[16:19], s31 offen nt
    s_add_u32 s31, s30, 40960
    buffer_load_dwordx4 v[84:87], v20, s[16:19], s31 offen nt
    s_add_u32 s31, s30, 49152
    buffer_load_dwordx4 v[88:91], v20, s[16:19], s31 offen nt
    s_add_u32 s31, s30, 57344
    buffer_load_dwordx4 v[92:95], v20, s[16:19], s31 offen nt
    s_add_u32 s31, s30, 4096
    buffer_load_dwordx4 v[96:99], v20, s[16:19], s31 offen nt
    s_add_u32 s31, s30, 12288
    buffer_load_dwordx4 v[100:103], v20, s[16:19], s31 offen nt
    s_add_u32 s31, s30, 20480
    buffer_load_dwordx4 v[104:107], v20, s[16:19], s31 offen nt
    s_add_u32 s31, s30, 28672
    buffer_load_dwordx4 v[108:111], v20, s[16:19], s31 offen nt
    s_add_u32 s31, s30, 36864
    buffer_load_dwordx4 v[112:115], v20, s[16:19], s31 offen nt
    s_add_u32 s31, s30, 45056
    buffer_load_dwordx4 v[116:119], v20, s[16:19], s31 offen nt
    s_add_u32 s31, s30, 53248
    buffer_load_dwordx4 v[120:123], v20, s[16:19], s31 offen nt
    s_add_u32 s31, s30, 61440
    buffer_load_dwordx4 v[124:127], v20, s[16:19], s31 offen nt
    s_branch L_tr
L_hw:
    s_cmp_ge_u32 s88, 28
    s_cbranch_scc1 L_srv
    s_mov_b32 s16, s44
    s_mov_b32 s17, s45
    s_mov_b32 s18, 1835008
    s_mov_b32 s19, 0x20000
    s_mov_b32 s20, s48
    s_mov_b32 s21, s49
    s_mov_b32 s22, 1835008
    s_mov_b32 s23, 0x20000
    v_mul_u32_u24 v20, 3584, v20
    v_add_u32 v20, v20, v21
    s_mul_i32 s30, s3, 458752
    s_lshl_b32 s31, s88, 7
    s_add_u32 s30, s30, s31
    s_add_u32 s31, s30, 0
    buffer_load_dwordx4 v[64:67], v20, s[16:19], s31 offen nt
    s_add_u32 s31, s30, 28672
    buffer_load_dwordx4 v[68:71], v20, s[16:19], s31 offen nt
    s_add_u32 s31, s30, 57344
    buffer_load_dwordx4 v[72:75], v20, s[16:19], s31 offen nt
    s_add_u32 s31, s30, 86016
    buffer_load_dwordx4 v[76:79], v20, s[16:19], s31 offen nt
    s_add_u32 s31, s30, 114688
    buffer_load_dwordx4 v[80:83], v20, s[16:19], s31 offen nt
    s_add_u32 s31, s30, 143360
    buffer_load_dwordx4 v[84:87], v20, s[16:19], s31 offen nt
    s_add_u32 s31, s30, 172032
    buffer_load_dwordx4 v[88:91], v20, s[16:19], s31 offen nt
    s_add_u32 s31, s30, 200704
    buffer_load_dwordx4 v[92:95], v20, s[16:19], s31 offen nt
    s_add_u32 s31, s30, 14336
    buffer_load_dwordx4 v[96:99], v20, s[16:19], s31 offen nt
    s_add_u32 s31, s30, 43008
    buffer_load_dwordx4 v[100:103], v20, s[16:19], s31 offen nt
    s_add_u32 s31, s30, 71680
    buffer_load_dwordx4 v[104:107], v20, s[16:19], s31 offen nt
    s_add_u32 s31, s30, 100352
    buffer_load_dwordx4 v[108:111], v20, s[16:19], s31 offen nt
    s_add_u32 s31, s30, 129024
    buffer_load_dwordx4 v[112:115], v20, s[16:19], s31 offen nt
    s_add_u32 s31, s30, 157696
    buffer_load_dwordx4 v[116:119], v20, s[16:19], s31 offen nt
    s_add_u32 s31, s30, 186368
    buffer_load_dwordx4 v[120:123], v20, s[16:19], s31 offen nt
    s_add_u32 s31, s30, 215040
    buffer_load_dwordx4 v[124:127], v20, s[16:19], s31 offen nt
    v_lshrrev_b32 v20, 4, v0
    v_lshlrev_b32 v20, 10, v20
    v_and_b32 v21, 15, v0
    v_lshl_add_u32 v20, v21, 4, v20
    s_lshl_b32 s30, s88, 16
    s_lshl_b32 s31, s3, 8
    s_add_u32 s30, s30, s31
    s_add_u32 s31, s30, 0
    buffer_load_dwordx4 v[224:227], v20, s[20:23], s31 offen nt
    s_add_u32 s31, s30, 8192
    buffer_load_dwordx4 v[228:231], v20, s[20:23], s31 offen nt
    s_add_u32 s31, s30, 16384
    buffer_load_dwordx4 v[232:235], v20, s[20:23], s31 offen nt
    s_add_u32 s31, s30, 24576
    buffer_load_dwordx4 v[236:239], v20, s[20:23], s31 offen nt
    s_add_u32 s31, s30, 32768
    buffer_load_dwordx4 v[240:243], v20, s[20:23], s31 offen nt
    s_add_u32 s31, s30, 40960
    buffer_load_dwordx4 v[244:247], v20, s[20:23], s31 offen nt
    s_add_u32 s31, s30, 49152
    buffer_load_dwordx4 v[248:251], v20, s[20:23], s31 offen nt
    s_add_u32 s31, s30, 57344
    buffer_load_dwordx4 v[252:255], v20, s[20:23], s31 offen nt
    s_add_u32 s31, s30, 4096
    buffer_load_dwordx4 v[32:35], v20, s[20:23], s31 offen nt
    s_add_u32 s31, s30, 12288
    buffer_load_dwordx4 v[36:39], v20, s[20:23], s31 offen nt
    s_add_u32 s31, s30, 20480
    buffer_load_dwordx4 v[40:43], v20, s[20:23], s31 offen nt
    s_add_u32 s31, s30, 28672
    buffer_load_dwordx4 v[44:47], v20, s[20:23], s31 offen nt
    s_add_u32 s31, s30, 36864
    buffer_load_dwordx4 v[48:51], v20, s[20:23], s31 offen nt
    s_add_u32 s31, s30, 45056
    buffer_load_dwordx4 v[52:55], v20, s[20:23], s31 offen nt
    s_add_u32 s31, s30, 53248
    buffer_load_dwordx4 v[56:59], v20, s[20:23], s31 offen nt
    s_add_u32 s31, s30, 61440
    buffer_load_dwordx4 v[60:63], v20, s[20:23], s31 offen nt
    s_mov_b32 s16, s46
    s_mov_b32 s17, s47
    s_mov_b32 s18, 3584
    s_mov_b32 s19, 0x20000
    v_bfe_u32 v20, v0, 2, 1
    v_lshlrev_b32 v20, 5, v20
    v_and_b32 v21, 3, v0
    v_lshl_add_u32 v20, v21, 3, v20
    v_lshrrev_b32 v21, 3, v0
    v_add_lshl_u32 v20, v20, v21, 1
    s_lshl_b32 s31, s88, 7
    buffer_load_ushort v8, v20, s[16:19], s31 offen
    v_and_b32 v20, 3, v0
    v_lshlrev_b32 v20, 5, v20
    v_bfe_u32 v21, v0, 2, 3
    v_add_u32 v20, v20, v21
    v_lshrrev_b32 v21, 5, v0
    v_lshl_add_u32 v20, v21, 4, v20
    s_lshl_b32 s31, s3, 7
    v_add_lshl_u32 v3, v20, s31, 1
    s_mov_b32 s16, s32
    s_mov_b32 s17, s33
    s_mov_b32 s18, 1024
    s_mov_b32 s19, 0x20000
    buffer_load_ushort v12, v3, s[16:19], 0 offen
    buffer_load_ushort v13, v3, s[16:19], 0 offen offset:16
    s_mov_b32 s16, s50
    s_mov_b32 s17, s51
    s_mov_b32 s18, 1024
    s_mov_b32 s19, 0x20000
    v_and_b32 v20, 1, v0
    v_lshlrev_b32 v20, 2, v20
    v_lshrrev_b32 v21, 4, v0
    v_add_u32 v20, v20, v21
    s_and_b32 s30, s88, 1
    s_lshl_b32 s30, s30, 3
    v_add_u32 v20, s30, v20
    s_bfe_u32 s30, s88, 0x30001
    s_add_u32 s92, s30, s31
    v_lshl_add_u32 v3, v20, 3, s92
    v_lshlrev_b32 v3, 1, v3
    s_lshl_b32 s30, s30, 4
    s_add_u32 s30, s30, s31
    v_add_lshl_u32 v15, v20, s30, 1
    buffer_load_ushort v14, v3, s[16:19], 0 offen
    s_mov_b32 s16, s52
    s_mov_b32 s17, s53
    s_mov_b32 s18, 1024
    s_mov_b32 s19, 0x20000
L_tr:
    s_waitcnt vmcnt(0)
    v_perm_b32 v128, v68, v64, s77
    v_perm_b32 v129, v76, v72, s77
    v_perm_b32 v130, v84, v80, s77
    v_perm_b32 v131, v92, v88, s77
    v_perm_b32 v132, v68, v64, s78
    v_perm_b32 v133, v76, v72, s78
    v_perm_b32 v134, v84, v80, s78
    v_perm_b32 v135, v92, v88, s78
    v_perm_b32 v136, v69, v65, s77
    v_perm_b32 v137, v77, v73, s77
    v_perm_b32 v138, v85, v81, s77
    v_perm_b32 v139, v93, v89, s77
    v_perm_b32 v140, v69, v65, s78
    v_perm_b32 v141, v77, v73, s78
    v_perm_b32 v142, v85, v81, s78
    v_perm_b32 v143, v93, v89, s78
    v_perm_b32 v144, v70, v66, s77
    v_perm_b32 v145, v78, v74, s77
    v_perm_b32 v146, v86, v82, s77
    v_perm_b32 v147, v94, v90, s77
    v_perm_b32 v148, v70, v66, s78
    v_perm_b32 v149, v78, v74, s78
    v_perm_b32 v150, v86, v82, s78
    v_perm_b32 v151, v94, v90, s78
    v_perm_b32 v152, v71, v67, s77
    v_perm_b32 v153, v79, v75, s77
    v_perm_b32 v154, v87, v83, s77
    v_perm_b32 v155, v95, v91, s77
    v_perm_b32 v156, v71, v67, s78
    v_perm_b32 v157, v79, v75, s78
    v_perm_b32 v158, v87, v83, s78
    v_perm_b32 v159, v95, v91, s78
    v_perm_b32 v160, v100, v96, s77
    v_perm_b32 v161, v108, v104, s77
    v_perm_b32 v162, v116, v112, s77
    v_perm_b32 v163, v124, v120, s77
    v_perm_b32 v164, v100, v96, s78
    v_perm_b32 v165, v108, v104, s78
    v_perm_b32 v166, v116, v112, s78
    v_perm_b32 v167, v124, v120, s78
    v_perm_b32 v168, v101, v97, s77
    v_perm_b32 v169, v109, v105, s77
    v_perm_b32 v170, v117, v113, s77
    v_perm_b32 v171, v125, v121, s77
    v_perm_b32 v172, v101, v97, s78
    v_perm_b32 v173, v109, v105, s78
    v_perm_b32 v174, v117, v113, s78
    v_perm_b32 v175, v125, v121, s78
    v_perm_b32 v176, v102, v98, s77
    v_perm_b32 v177, v110, v106, s77
    v_perm_b32 v178, v118, v114, s77
    v_perm_b32 v179, v126, v122, s77
    v_perm_b32 v180, v102, v98, s78
    v_perm_b32 v181, v110, v106, s78
    v_perm_b32 v182, v118, v114, s78
    v_perm_b32 v183, v126, v122, s78
    v_perm_b32 v184, v103, v99, s77
    v_perm_b32 v185, v111, v107, s77
    v_perm_b32 v186, v119, v115, s77
    v_perm_b32 v187, v127, v123, s77
    v_perm_b32 v188, v103, v99, s78
    v_perm_b32 v189, v111, v107, s78
    v_perm_b32 v190, v119, v115, s78
    v_perm_b32 v191, v127, v123, s78
    v_perm_b32 v192, v228, v224, s77
    v_perm_b32 v193, v236, v232, s77
    v_perm_b32 v194, v244, v240, s77
    v_perm_b32 v195, v252, v248, s77
    v_perm_b32 v196, v228, v224, s78
    v_perm_b32 v197, v236, v232, s78
    v_perm_b32 v198, v244, v240, s78
    v_perm_b32 v199, v252, v248, s78
    v_perm_b32 v200, v229, v225, s77
    v_perm_b32 v201, v237, v233, s77
    v_perm_b32 v202, v245, v241, s77
    v_perm_b32 v203, v253, v249, s77
    v_perm_b32 v204, v229, v225, s78
    v_perm_b32 v205, v237, v233, s78
    v_perm_b32 v206, v245, v241, s78
    v_perm_b32 v207, v253, v249, s78
    v_perm_b32 v208, v230, v226, s77
    v_perm_b32 v209, v238, v234, s77
    v_perm_b32 v210, v246, v242, s77
    v_perm_b32 v211, v254, v250, s77
    v_perm_b32 v212, v230, v226, s78
    v_perm_b32 v213, v238, v234, s78
    v_perm_b32 v214, v246, v242, s78
    v_perm_b32 v215, v254, v250, s78
    v_perm_b32 v216, v231, v227, s77
    v_perm_b32 v217, v239, v235, s77
    v_perm_b32 v218, v247, v243, s77
    v_perm_b32 v219, v255, v251, s77
    v_perm_b32 v220, v231, v227, s78
    v_perm_b32 v221, v239, v235, s78
    v_perm_b32 v222, v247, v243, s78
    v_perm_b32 v223, v255, v251, s78
    v_perm_b32 v224, v36, v32, s77
    v_perm_b32 v225, v44, v40, s77
    v_perm_b32 v226, v52, v48, s77
    v_perm_b32 v227, v60, v56, s77
    v_perm_b32 v228, v36, v32, s78
    v_perm_b32 v229, v44, v40, s78
    v_perm_b32 v230, v52, v48, s78
    v_perm_b32 v231, v60, v56, s78
    v_perm_b32 v232, v37, v33, s77
    v_perm_b32 v233, v45, v41, s77
    v_perm_b32 v234, v53, v49, s77
    v_perm_b32 v235, v61, v57, s77
    v_perm_b32 v236, v37, v33, s78
    v_perm_b32 v237, v45, v41, s78
    v_perm_b32 v238, v53, v49, s78
    v_perm_b32 v239, v61, v57, s78
    v_perm_b32 v240, v38, v34, s77
    v_perm_b32 v241, v46, v42, s77
    v_perm_b32 v242, v54, v50, s77
    v_perm_b32 v243, v62, v58, s77
    v_perm_b32 v244, v38, v34, s78
    v_perm_b32 v245, v46, v42, s78
    v_perm_b32 v246, v54, v50, s78
    v_perm_b32 v247, v62, v58, s78
    v_perm_b32 v248, v39, v35, s77
    v_perm_b32 v249, v47, v43, s77
    v_perm_b32 v250, v55, v51, s77
    v_perm_b32 v251, v63, v59, s77
    v_perm_b32 v252, v39, v35, s78
    v_perm_b32 v253, v47, v43, s78
    v_perm_b32 v254, v55, v51, s78
    v_perm_b32 v255, v63, v59, s78
    v_lshlrev_b32 v8, 16, v8
    v_lshlrev_b32 v12, 16, v12
    v_lshlrev_b32 v13, 16, v13
    v_lshlrev_b32 v14, 16, v14
L_srv:
    s_lshl_b32 s95, s3, 2
    s_add_u32 s94, s95, 208
    s_lshr_b32 s92, s2, 5
    s_lshl_b32 s92, s92, 2
    s_lshr_b32 s31, s3, 2
    s_add_u32 s92, s92, s31
    s_lshl_b32 s92, s92, 8
    s_add_u32 s92, s92, 4096
    s_lshl_b32 s93, s31, 15
    s_mov_b32 s63, 2000000
    v_mov_b32 v21, s95
    v_not_b32 v24, v9
    s_mov_b64 exec, 1
L_sv:
    s_sub_u32 s63, s63, 1
    s_cmp_eq_u32 s63, 0
    s_cbranch_scc1 L_sve
    ds_read_b32 v20, v21 offset:32
    s_waitcnt lgkmcnt(0)
    v_readfirstlane_b32 s30, v20
    s_cmp_ge_u32 s30, s94
    s_cbranch_scc1 L_svd
    s_sleep 2
    s_branch L_sv
    s_cmp_lt_u32 s30, 192
    s_cbranch_scc1 L_sv
    s_and_b32 s31, s63, 3
    s_cbranch_scc1 L_sv
    s_waitcnt vmcnt(2)
    buffer_load_dword v24, v10, s[12:15], s92 offen offset:128 sc1
    s_branch L_sv
L_svd:
    v_mov_b32 v20, 1
    buffer_atomic_add v20, v10, s[12:15], s92 offen sc0 sc1
    v_mov_b32 v22, s94
    s_waitcnt vmcnt(0)
    v_readfirstlane_b32 s30, v20
    s_cmp_lt_u32 s30, 2047
    s_branch L_svn
    buffer_store_dword v9, v10, s[12:15], s92 offen offset:128 sc1
    v_mov_b32 v24, v9
L_svn:
    s_lshr_b32 s27, s30, 9
    s_cmp_ge_u32 s27, 4
    s_cbranch_scc1 L_sve
    s_lshl_b32 s27, s27, 22
    s_bfe_u32 s31, s30, 0x50002
    s_lshl_b32 s31, s31, 17
    s_add_u32 s27, s27, s31
    s_bfe_u32 s31, s30, 0x20007
    s_lshl_b32 s31, s31, 15
    s_add_u32 s27, s27, s31
    s_and_b32 s31, s30, 3
    s_lshl_b32 s31, s31, 13
    s_add_u32 s27, s27, s31
    s_add_u32 s27, s27, s93
    v_mov_b32 v23, s27
    ds_write_b32 v22, v23 offset:1536
    s_add_u32 s94, s94, 16
    s_cmp_lt_u32 s94, 496
    s_cbranch_scc1 L_sv
L_sve:
    v_mov_b32 v22, s94
    v_bfrev_b32 v23, 1
    ds_write_b32 v22, v23 offset:1536
    s_mov_b64 exec, -1
    s_waitcnt vmcnt(0)
    s_cmp_lt_u32 s88, 28
    s_cbranch_scc1 L_t3
    s_cmp_lt_u32 s25, 24
    s_cbranch_scc1 L_exit
    s_branch L_t2
L_t3:
    s_mov_b64 exec, s[60:61]
    v_and_b32 v23, 31, v0
    v_lshlrev_b32 v23, 3, v23
    v_lshrrev_b32 v22, 5, v0
    v_lshl_add_u32 v23, v22, 2, v23
    s_lshl_b32 s31, s3, 8
    v_add_u32 v23, s31, v23
    v_lshrrev_b32 v22, 4, v0
    v_lshlrev_b32 v22, 4, v22
    v_and_b32 v16, 1, v0
    v_lshl_add_u32 v16, v16, 6, v22
    v_add_u32 v16, s31, v16
    v_lshrrev_b32 v17, 5, v0
    v_lshlrev_b32 v17, 8, v17
    v_bfe_u32 v18, v0, 4, 1
    v_lshl_add_u32 v17, v18, 4, v17
    s_lshl_b32 s31, s3, 9
    v_add_u32 v17, s31, v17
    v_and_b32 v21, 15, v0
    v_lshlrev_b32 v21, 5, v21
    v_lshrrev_b32 v18, 5, v0
    v_lshl_add_u32 v21, v18, 4, v21
    s_lshl_b32 s30, s24, 2
    s_add_u32 s30, s30, s3
    s_lshl_b32 s96, s30, 9
    s_add_u32 s96, s96, 655360
    s_lshl_b32 s92, s3, 12
    s_add_u32 s92, s92, 720896
    s_lshl_b32 s93, s3, 14
    s_add_u32 s93, s93, 786432
    s_lshl_b32 s97, s88, 5
    s_add_u32 s97, s97, s93
    s_lshl_b32 s31, s88, 10
    s_add_u32 s93, s93, s31
    v_and_b32 v1, 7, v0
    v_lshlrev_b32 v1, 11, v1
    v_lshrrev_b32 v18, 5, v0
    v_lshl_add_u32 v1, v18, 10, v1
    v_bfe_u32 v18, v0, 4, 1
    v_lshl_add_u32 v1, v18, 4, v1
    v_lshlrev_b32 v18, 2, v0
    s_lshl_b32 s31, s3, 7
    v_lshl_add_u32 v19, v0, 1, s31
    v_add_u32 v22, s31, v22
    v_mov_b32 v88, 0
    v_mov_b32 v89, 0
    v_mov_b32 v90, 0
    v_mov_b32 v91, 0
    s_cbranch_execz Lpd_42
    s_mov_b32 s63, 1000000
Lp_41:
    buffer_load_dwordx4 v[64:67], v21, s[12:15], s96 offen sc1
    s_waitcnt vmcnt(0)
    v_xor_b32 v20, v64, v4
    v_bitop3_b32 v20, v20, v65, v5 bitop3:0xf6
    v_bitop3_b32 v20, v20, v66, v6 bitop3:0xf6
    v_bitop3_b32 v20, v20, v67, v7 bitop3:0xf6
    v_and_b32 v20, 0xff, v20
    v_cmp_eq_u32 vcc, 0, v20
    s_bcnt1_i32_b64 s30, vcc
    s_cmp_ge_u32 s30, 64
    s_cbranch_scc1 Lpd_42
    s_sub_u32 s63, s63, 1
    s_cmp_lg_u32 s63, 0
    s_cbranch_scc1 Lp_41
Lpd_42:
    s_mov_b64 s[64:65], s[60:61]
    s_mov_b32 s63, 1000000
Lg_43:
    s_mov_b64 exec, s[64:65]
    s_cbranch_execz Ls_45
    buffer_load_dwordx4 v[64:67], v2, s[12:15], s92 offen offset:0 sc1
    buffer_load_dwordx4 v[68:71], v2, s[12:15], s92 offen offset:1024 sc1
    buffer_load_dwordx4 v[72:75], v2, s[12:15], s92 offen offset:2048 sc1
    buffer_load_dwordx4 v[76:79], v2, s[12:15], s92 offen offset:3072 sc1
Ls_45:
    s_mov_b64 s[86:87], 0
    s_waitcnt vmcnt(0)
    s_mov_b64 exec, s[64:65]
    s_cbranch_execz Ls_46
    v_xor_b32 v20, v64, v4
    v_bitop3_b32 v20, v20, v65, v5 bitop3:0xf6
    v_bitop3_b32 v20, v20, v66, v6 bitop3:0xf6
    v_bitop3_b32 v20, v20, v67, v7 bitop3:0xf6
    v_bitop3_b32 v20, v20, v68, v4 bitop3:0xf6
    v_bitop3_b32 v20, v20, v69, v5 bitop3:0xf6
    v_bitop3_b32 v20, v20, v70, v6 bitop3:0xf6
    v_bitop3_b32 v20, v20, v71, v7 bitop3:0xf6
    v_bitop3_b32 v20, v20, v72, v4 bitop3:0xf6
    v_bitop3_b32 v20, v20, v73, v5 bitop3:0xf6
    v_bitop3_b32 v20, v20, v74, v6 bitop3:0xf6
    v_bitop3_b32 v20, v20, v75, v7 bitop3:0xf6
    v_bitop3_b32 v20, v20, v76, v4 bitop3:0xf6
    v_bitop3_b32 v20, v20, v77, v5 bitop3:0xf6
    v_bitop3_b32 v20, v20, v78, v6 bitop3:0xf6
    v_bitop3_b32 v20, v20, v79, v7 bitop3:0xf6
    v_and_b32 v20, 0xff, v20
    v_cmp_ne_u32 s[64:65], 0, v20
    s_or_b64 s[86:87], s[86:87], s[64:65]
Ls_46:
    s_cmp_eq_u64 s[86:87], 0
    s_cbranch_scc1 Lgd_44
    s_sub_u32 s63, s63, 1
    s_cmp_lg_u32 s63, 0
    s_cbranch_scc1 Lg_43
Lgd_44:
    s_mov_b64 exec, s[60:61]
    v_add_f32 v32, v64, v68
    v_add_f32 v33, v65, v69
    v_add_f32 v34, v66, v70
    v_add_f32 v35, v67, v71
    v_add_f32 v36, v72, v76
    v_add_f32 v37, v73, v77
    v_add_f32 v38, v74, v78
    v_add_f32 v39, v75, v79
    v_add_f32 v32, v32, v36
    v_add_f32 v33, v33, v37
    v_add_f32 v34, v34, v38
    v_add_f32 v35, v35, v39
    s_nop 0
    v_permlane32_swap_b32 v32, v34
    v_permlane32_swap_b32 v33, v35
    v_add_f32 v32, v32, v34
    v_add_f32 v33, v33, v35
    v_cvt_pk_bf16_f32 v32, 0, v32
    v_cvt_pk_bf16_f32 v33, 0, v33
    v_add_f32 v12, v12, v32
    v_add_f32 v13, v13, v33
    v_cvt_pk_bf16_f32 v20, v12, v13
    ds_write_b32 v23, v20 offset:12800
    s_waitcnt lgkmcnt(0)
    s_cbranch_execz L_b3
    s_barrier
L_b3:
    ds_read_b128 v[24:27], v2 offset:12800
    ds_read_u16 v12, v15 offset:12800
    s_waitcnt lgkmcnt(1)
    v_lshlrev_b32 v28, 16, v24
    v_and_b32 v29, 0xffff0000, v24
    v_lshlrev_b32 v30, 16, v25
    v_and_b32 v31, 0xffff0000, v25
    v_lshlrev_b32 v32, 16, v26
    v_and_b32 v33, 0xffff0000, v26
    v_lshlrev_b32 v34, 16, v27
    v_and_b32 v35, 0xffff0000, v27
    v_readfirstlane_b32 s30, v28
    s_nop 1
    v_subrev_f32 v40, s30, v28
    v_subrev_f32 v41, s30, v29
    v_subrev_f32 v42, s30, v30
    v_subrev_f32 v43, s30, v31
    v_subrev_f32 v44, s30, v32
    v_subrev_f32 v45, s30, v33
    v_subrev_f32 v46, s30, v34
    v_subrev_f32 v47, s30, v35
    v_add_f32 v48, v40, v41
    v_mul_f32 v49, v40, v40
    v_add_f32 v50, v42, v43
    v_mul_f32 v51, v41, v41
    v_add_f32 v48, v48, v44
    v_fmac_f32 v49, v42, v42
    v_add_f32 v50, v50, v45
    v_fmac_f32 v51, v43, v43
    v_add_f32 v48, v48, v46
    v_fmac_f32 v49, v44, v44
    v_add_f32 v50, v50, v47
    v_fmac_f32 v51, v45, v45
    v_fmac_f32 v49, v46, v46
    v_fmac_f32 v51, v47, v47
    v_add_f32 v48, v48, v50
    v_add_f32 v49, v49, v51
    s_nop 1
    v_permlane32_swap_b32 v48, v49
    v_add_f32 v48, v48, v49
    s_nop 1
    v_add_f32_dpp v48, v48, v48 row_ror:8 row_mask:0xf bank_mask:0xf
    s_nop 1
    v_add_f32_dpp v48, v48, v48 row_ror:4 row_mask:0xf bank_mask:0xf
    s_nop 1
    v_add_f32_dpp v48, v48, v48 row_ror:2 row_mask:0xf bank_mask:0xf
    s_nop 1
    v_add_f32_dpp v48, v48, v48 row_ror:1 row_mask:0xf bank_mask:0xf
    s_nop 0
    v_readlane_b32 s31, v48, 0
    v_readlane_b32 s89, v48, 16
    v_readlane_b32 s90, v48, 32
    v_readlane_b32 s91, v48, 48
    v_mov_b32 v40, s31
    v_mov_b32 v41, s90
    v_add_f32 v40, s89, v40
    v_add_f32 v41, s91, v41
    v_mul_f32 v40, 0x3b000000, v40
    v_mul_f32 v41, 0x3b000000, v41
    v_fma_f32 v41, -v40, v40, v41
    v_add_f32 v40, s30, v40
    v_max_f32 v41, 0, v41
    v_cvt_pk_bf16_f32 v41, 0, v41
    v_cvt_pk_bf16_f32 v40, 0, v40
    v_add_f32 v41, 0x3727c5ac, v41
    v_cvt_pk_bf16_f32 v41, 0, v41
    v_sqrt_f32 v41, v41
    v_sub_f32 v28, v28, v40
    v_sub_f32 v29, v29, v40
    v_sub_f32 v30, v30, v40
    v_sub_f32 v31, v31, v40
    v_sub_f32 v32, v32, v40
    v_sub_f32 v33, v33, v40
    v_sub_f32 v34, v34, v40
    v_sub_f32 v35, v35, v40
    v_cvt_pk_bf16_f32 v41, 0, v41
    v_rcp_f32 v42, v41
    v_cvt_pk_bf16_f32 v28, 0, v28
    v_cvt_pk_bf16_f32 v29, 0, v29
    v_cvt_pk_bf16_f32 v30, 0, v30
    v_cvt_pk_bf16_f32 v31, 0, v31
    v_cvt_pk_bf16_f32 v32, 0, v32
    v_cvt_pk_bf16_f32 v33, 0, v33
    v_cvt_pk_bf16_f32 v34, 0, v34
    v_cvt_pk_bf16_f32 v35, 0, v35
    v_mul_f32 v43, v28, v42
    v_mul_f32 v44, v29, v42
    v_mul_f32 v45, v30, v42
    v_mul_f32 v46, v31, v42
    v_mul_f32 v47, v32, v42
    v_mul_f32 v48, v33, v42
    v_mul_f32 v49, v34, v42
    v_mul_f32 v50, v35, v42
    v_fma_f32 v28, -v43, v41, v28
    v_fma_f32 v29, -v44, v41, v29
    v_fma_f32 v30, -v45, v41, v30
    v_fma_f32 v31, -v46, v41, v31
    v_fma_f32 v32, -v47, v41, v32
    v_fma_f32 v33, -v48, v41, v33
    v_fma_f32 v34, -v49, v41, v34
    v_fma_f32 v35, -v50, v41, v35
    v_fmac_f32 v43, v28, v42
    v_fmac_f32 v44, v29, v42
    v_fmac_f32 v45, v30, v42
    v_fmac_f32 v46, v31, v42
    v_fmac_f32 v47, v32, v42
    v_fmac_f32 v48, v33, v42
    v_fmac_f32 v49, v34, v42
    v_fmac_f32 v50, v35, v42
    v_cvt_pk_bf16_f32 v28, 0, v43
    v_cvt_pk_bf16_f32 v29, 0, v44
    v_cvt_pk_bf16_f32 v30, 0, v45
    v_cvt_pk_bf16_f32 v31, 0, v46
    v_cvt_pk_bf16_f32 v32, 0, v47
    v_cvt_pk_bf16_f32 v33, 0, v48
    v_cvt_pk_bf16_f32 v34, 0, v49
    v_cvt_pk_bf16_f32 v35, 0, v50
    v_readfirstlane_b32 s30, v28
    s_nop 1
    v_subrev_f32 v40, s30, v28
    v_subrev_f32 v41, s30, v29
    v_subrev_f32 v42, s30, v30
    v_subrev_f32 v43, s30, v31
    v_subrev_f32 v44, s30, v32
    v_subrev_f32 v45, s30, v33
    v_subrev_f32 v46, s30, v34
    v_subrev_f32 v47, s30, v35
    v_add_f32 v48, v40, v41
    v_mul_f32 v49, v40, v40
    v_add_f32 v50, v42, v43
    v_mul_f32 v51, v41, v41
    v_add_f32 v48, v48, v44
    v_fmac_f32 v49, v42, v42
    v_add_f32 v50, v50, v45
    v_fmac_f32 v51, v43, v43
    v_add_f32 v48, v48, v46
    v_fmac_f32 v49, v44, v44
    v_add_f32 v50, v50, v47
    v_fmac_f32 v51, v45, v45
    v_fmac_f32 v49, v46, v46
    v_fmac_f32 v51, v47, v47
    v_add_f32 v48, v48, v50
    v_add_f32 v49, v49, v51
    s_nop 1
    v_permlane32_swap_b32 v48, v49
    v_add_f32 v48, v48, v49
    s_nop 1
    v_add_f32_dpp v48, v48, v48 row_ror:8 row_mask:0xf bank_mask:0xf
    s_nop 1
    v_add_f32_dpp v48, v48, v48 row_ror:4 row_mask:0xf bank_mask:0xf
    s_nop 1
    v_add_f32_dpp v48, v48, v48 row_ror:2 row_mask:0xf bank_mask:0xf
    s_nop 1
    v_add_f32_dpp v48, v48, v48 row_ror:1 row_mask:0xf bank_mask:0xf
    s_nop 0
    v_readlane_b32 s31, v48, 0
    v_readlane_b32 s89, v48, 16
    v_readlane_b32 s90, v48, 32
    v_readlane_b32 s91, v48, 48
    v_mov_b32 v40, s31
    v_mov_b32 v41, s90
    v_add_f32 v40, s89, v40
    v_add_f32 v41, s91, v41
    v_mul_f32 v40, 0x3b000000, v40
    v_mul_f32 v41, 0x3b000000, v41
    v_fma_f32 v41, -v40, v40, v41
    v_add_f32 v40, s30, v40
    v_max_f32 v41, 0, v41
    v_cvt_pk_bf16_f32 v41, 0, v41
    v_cvt_pk_bf16_f32 v40, 0, v40
    v_add_f32 v41, 0x3727c5ac, v41
    v_cvt_pk_bf16_f32 v41, 0, v41
    v_sqrt_f32 v41, v41
    v_sub_f32 v28, v28, v40
    v_sub_f32 v29, v29, v40
    v_sub_f32 v30, v30, v40
    v_sub_f32 v31, v31, v40
    v_sub_f32 v32, v32, v40
    v_sub_f32 v33, v33, v40
    v_sub_f32 v34, v34, v40
    v_sub_f32 v35, v35, v40
    v_cvt_pk_bf16_f32 v41, 0, v41
    v_rcp_f32 v42, v41
    v_cvt_pk_bf16_f32 v28, 0, v28
    v_cvt_pk_bf16_f32 v29, 0, v29
    v_cvt_pk_bf16_f32 v30, 0, v30
    v_cvt_pk_bf16_f32 v31, 0, v31
    v_cvt_pk_bf16_f32 v32, 0, v32
    v_cvt_pk_bf16_f32 v33, 0, v33
    v_cvt_pk_bf16_f32 v34, 0, v34
    v_cvt_pk_bf16_f32 v35, 0, v35
    v_mul_f32 v43, v28, v42
    v_mul_f32 v44, v29, v42
    v_mul_f32 v45, v30, v42
    v_mul_f32 v46, v31, v42
    v_mul_f32 v47, v32, v42
    v_mul_f32 v48, v33, v42
    v_mul_f32 v49, v34, v42
    v_mul_f32 v50, v35, v42
    v_fma_f32 v28, -v43, v41, v28
    v_fma_f32 v29, -v44, v41, v29
    v_fma_f32 v30, -v45, v41, v30
    v_fma_f32 v31, -v46, v41, v31
    v_fma_f32 v32, -v47, v41, v32
    v_fma_f32 v33, -v48, v41, v33
    v_fma_f32 v34, -v49, v41, v34
    v_fma_f32 v35, -v50, v41, v35
    v_fmac_f32 v43, v28, v42
    v_fmac_f32 v44, v29, v42
    v_fmac_f32 v45, v30, v42
    v_fmac_f32 v46, v31, v42
    v_fmac_f32 v47, v32, v42
    v_fmac_f32 v48, v33, v42
    v_fmac_f32 v49, v34, v42
    v_fmac_f32 v50, v35, v42
    v_cvt_pk_bf16_f32 v28, 0, v43
    v_cvt_pk_bf16_f32 v29, 0, v44
    v_cvt_pk_bf16_f32 v30, 0, v45
    v_cvt_pk_bf16_f32 v31, 0, v46
    v_cvt_pk_bf16_f32 v32, 0, v47
    v_cvt_pk_bf16_f32 v33, 0, v48
    v_cvt_pk_bf16_f32 v34, 0, v49
    v_cvt_pk_bf16_f32 v35, 0, v50
    v_perm_b32 v24, v29, v28, s78
    v_perm_b32 v25, v31, v30, s78
    v_perm_b32 v26, v33, v32, s78
    v_perm_b32 v27, v35, v34, s78
    ds_write_b128 v2, v[24:27] offset:13824
    ds_read_b128 v[80:83], v16 offset:13824
    ds_read_b128 v[84:87], v16 offset:13952
    s_waitcnt lgkmcnt(1)
    v_mfma_f32_16x16x32_bf16 v[32:35], v[128:131], v[80:83], 0
    v_mfma_f32_16x16x32_bf16 v[36:39], v[132:135], v[80:83], 0
    v_mfma_f32_16x16x32_bf16 v[40:43], v[136:139], v[80:83], 0
    v_mfma_f32_16x16x32_bf16 v[44:47], v[140:143], v[80:83], 0
    v_mfma_f32_16x16x32_bf16 v[48:51], v[144:147], v[80:83], 0
    v_mfma_f32_16x16x32_bf16 v[52:55], v[148:151], v[80:83], 0
    v_mfma_f32_16x16x32_bf16 v[56:59], v[152:155], v[80:83], 0
    v_mfma_f32_16x16x32_bf16 v[60:63], v[156:159], v[80:83], 0
    s_waitcnt lgkmcnt(0)
    v_mfma_f32_16x16x32_bf16 v[32:35], v[160:163], v[84:87], v[32:35]
    v_mfma_f32_16x16x32_bf16 v[36:39], v[164:167], v[84:87], v[36:39]
    v_mfma_f32_16x16x32_bf16 v[40:43], v[168:171], v[84:87], v[40:43]
    v_mfma_f32_16x16x32_bf16 v[44:47], v[172:175], v[84:87], v[44:47]
    v_mfma_f32_16x16x32_bf16 v[48:51], v[176:179], v[84:87], v[48:51]
    v_mfma_f32_16x16x32_bf16 v[52:55], v[180:183], v[84:87], v[52:55]
    v_mfma_f32_16x16x32_bf16 v[56:59], v[184:187], v[84:87], v[56:59]
    v_mfma_f32_16x16x32_bf16 v[60:63], v[188:191], v[84:87], v[60:63]
    s_and_b32 exec_lo, s60, 0x10001
    s_and_b32 exec_hi, s61, 0x20002
    ds_write_b128 v17, v[32:35] offset:14848
    ds_write_b128 v17, v[36:39] offset:14880
    ds_write_b128 v17, v[40:43] offset:14912
    ds_write_b128 v17, v[44:47] offset:14944
    ds_write_b128 v17, v[48:51] offset:14976
    ds_write_b128 v17, v[52:55] offset:15008
    ds_write_b128 v17, v[56:59] offset:15040
    ds_write_b128 v17, v[60:63] offset:15072
    s_mov_b64 exec, s[60:61]
    s_waitcnt lgkmcnt(0)
    s_cbranch_execz L_b4
    s_barrier
L_b4:
    ds_read_b32 v24, v18 offset:14848
    ds_read_b32 v25, v18 offset:15104
    ds_read_b32 v26, v18 offset:15360
    ds_read_b32 v27, v18 offset:15616
    ds_read_b32 v28, v18 offset:15872
    ds_read_b32 v29, v18 offset:16128
    ds_read_b32 v30, v18 offset:16384
    ds_read_b32 v31, v18 offset:16640
    s_waitcnt lgkmcnt(0)
    v_add_f32 v24, v24, v25
    v_add_f32 v26, v26, v27
    v_add_f32 v28, v28, v29
    v_add_f32 v30, v30, v31
    v_add_f32 v24, v24, v26
    v_add_f32 v28, v28, v30
    v_add_f32 v24, v24, v28
    v_cvt_pk_bf16_f32 v24, 0, v24
    v_add_f32 v24, v24, v8
    v_cvt_pk_bf16_f32 v24, 0, v24
    v_mul_f32 v25, v24, v24
    v_mov_b32 v26, 0xc0135761
    v_fmac_f32 v26, 0xbdd2d3e8, v25
    v_mul_f32 v25, v24, v26
    v_exp_f32 v25, v25
    s_nop 0
    v_add_f32 v25, 1.0, v25
    v_rcp_f32 v25, v25
    s_nop 0
    v_mul_f32 v24, v24, v25
    v_cvt_pk_bf16_f32 v24, v24, v24
    ds_write_b16 v19, v24 offset:16896
    ds_read_b128 v[80:83], v22 offset:16896
    ds_read_b128 v[84:87], v22 offset:16960
    s_waitcnt lgkmcnt(1)
    v_mfma_f32_16x16x32_bf16 v[32:35], v[192:195], v[80:83], 0
    v_mfma_f32_16x16x32_bf16 v[36:39], v[196:199], v[80:83], 0
    v_mfma_f32_16x16x32_bf16 v[40:43], v[200:203], v[80:83], 0
    v_mfma_f32_16x16x32_bf16 v[44:47], v[204:207], v[80:83], 0
    v_mfma_f32_16x16x32_bf16 v[48:51], v[208:211], v[80:83], 0
    v_mfma_f32_16x16x32_bf16 v[52:55], v[212:215], v[80:83], 0
    v_mfma_f32_16x16x32_bf16 v[56:59], v[216:219], v[80:83], 0
    v_mfma_f32_16x16x32_bf16 v[60:63], v[220:223], v[80:83], 0
    s_waitcnt lgkmcnt(0)
    v_mfma_f32_16x16x32_bf16 v[32:35], v[224:227], v[84:87], v[32:35]
    v_mfma_f32_16x16x32_bf16 v[36:39], v[228:231], v[84:87], v[36:39]
    v_mfma_f32_16x16x32_bf16 v[40:43], v[232:235], v[84:87], v[40:43]
    v_mfma_f32_16x16x32_bf16 v[44:47], v[236:239], v[84:87], v[44:47]
    v_mfma_f32_16x16x32_bf16 v[48:51], v[240:243], v[84:87], v[48:51]
    v_mfma_f32_16x16x32_bf16 v[52:55], v[244:247], v[84:87], v[52:55]
    v_mfma_f32_16x16x32_bf16 v[56:59], v[248:251], v[84:87], v[56:59]
    v_mfma_f32_16x16x32_bf16 v[60:63], v[252:255], v[84:87], v[60:63]
    s_and_b32 exec_lo, s60, 0x10001
    s_and_b32 exec_hi, s61, 0x10001
    v_bfi_b32 v24, s76, v4, v32
    v_bfi_b32 v25, s76, v5, v33
    v_bfi_b32 v26, s76, v6, v34
    v_bfi_b32 v27, s76, v7, v35
    s_and_b32 exec_lo, s60, 0x20002
    s_and_b32 exec_hi, s61, 0x20002
    v_bfi_b32 v24, s76, v4, v36
    v_bfi_b32 v25, s76, v5, v37
    v_bfi_b32 v26, s76, v6, v38
    v_bfi_b32 v27, s76, v7, v39
    s_and_b32 exec_lo, s60, 0x40004
    s_and_b32 exec_hi, s61, 0x40004
    v_bfi_b32 v24, s76, v4, v40
    v_bfi_b32 v25, s76, v5, v41
    v_bfi_b32 v26, s76, v6, v42
    v_bfi_b32 v27, s76, v7, v43
    s_and_b32 exec_lo, s60, 0x80008
    s_and_b32 exec_hi, s61, 0x80008
    v_bfi_b32 v24, s76, v4, v44
    v_bfi_b32 v25, s76, v5, v45
    v_bfi_b32 v26, s76, v6, v46
    v_bfi_b32 v27, s76, v7, v47
    s_and_b32 exec_lo, s60, 0x100010
    s_and_b32 exec_hi, s61, 0x100010
    v_bfi_b32 v24, s76, v4, v48
    v_bfi_b32 v25, s76, v5, v49
    v_bfi_b32 v26, s76, v6, v50
    v_bfi_b32 v27, s76, v7, v51
    s_and_b32 exec_lo, s60, 0x200020
    s_and_b32 exec_hi, s61, 0x200020
    v_bfi_b32 v24, s76, v4, v52
    v_bfi_b32 v25, s76, v5, v53
    v_bfi_b32 v26, s76, v6, v54
    v_bfi_b32 v27, s76, v7, v55
    s_and_b32 exec_lo, s60, 0x400040
    s_and_b32 exec_hi, s61, 0x400040
    v_bfi_b32 v24, s76, v4, v56
    v_bfi_b32 v25, s76, v5, v57
    v_bfi_b32 v26, s76, v6, v58
    v_bfi_b32 v27, s76, v7, v59
    s_and_b32 exec_lo, s60, 0x800080
    s_and_b32 exec_hi, s61, 0x800080
    v_bfi_b32 v24, s76, v4, v60
    v_bfi_b32 v25, s76, v5, v61
    v_bfi_b32 v26, s76, v6, v62
    v_bfi_b32 v27, s76, v7, v63
    s_and_b32 exec_lo, s60, 0xff00ff
    s_and_b32 exec_hi, s61, 0xff00ff
    s_cbranch_execz L_t4
    buffer_store_dwordx4 v[24:27], v1, s[12:15], s97 offen sc1
    s_cmp_ge_u32 s88, 16
    s_cbranch_scc1 L_exit
L_t4:
    s_and_b32 exec_lo, s60, 0xffffffff
    s_and_b32 exec_hi, s61, 0xffffff
    s_and_b32 s64, s60, 0xffffffff
    s_and_b32 s65, s61, 0xffffff
    s_mov_b32 s63, 1000000
Lg_47:
    s_mov_b64 exec, s[64:65]
    s_cbranch_execz Ls_49
    buffer_load_dwordx4 v[88:91], v2, s[12:15], s93 offen offset:0 sc1
Ls_49:
    s_mov_b64 s[86:87], 0
    s_waitcnt vmcnt(0)
    s_mov_b64 exec, s[64:65]
    s_cbranch_execz Ls_50
    v_xor_b32 v20, v88, v4
    v_bitop3_b32 v20, v20, v89, v5 bitop3:0xf6
    v_bitop3_b32 v20, v20, v90, v6 bitop3:0xf6
    v_bitop3_b32 v20, v20, v91, v7 bitop3:0xf6
    v_and_b32 v20, 0xff, v20
    v_cmp_ne_u32 s[64:65], 0, v20
    s_or_b64 s[86:87], s[86:87], s[64:65]
Ls_50:
    s_cmp_eq_u64 s[86:87], 0
    s_cbranch_scc1 Lgd_48
    s_sub_u32 s63, s63, 1
    s_cmp_lg_u32 s63, 0
    s_cbranch_scc1 Lg_47
Lgd_48:
    s_mov_b64 exec, s[60:61]
    v_mov_b32 v24, v88
    v_mov_b32 v25, v89
    v_mov_b32 v26, v90
    v_mov_b32 v27, v91
    v_lshlrev_b32 v12, 16, v12
    v_permlane32_swap_b32 v24, v26
    v_permlane32_swap_b32 v25, v27
    v_add_f32 v24, v24, v26
    v_add_f32 v25, v25, v27
    s_nop 1
    v_permlane16_swap_b32 v24, v25
    v_add_f32 v24, v24, v25
    s_nop 1
    v_add_f32_dpp v24, v24, v24 row_ror:8 row_mask:0xf bank_mask:0xf
    s_nop 1
    v_add_f32_dpp v24, v24, v24 row_ror:4 row_mask:0xf bank_mask:0xf
    s_nop 1
    v_add_f32_dpp v24, v24, v24 row_ror:2 row_mask:0xf bank_mask:0xf
    v_cvt_pk_bf16_f32 v24, 0, v24
    v_add_f32 v24, v24, v14
    v_cvt_pk_bf16_f32 v24, 0, v24
    v_add_f32 v24, v24, v12
    v_cvt_pk_bf16_f32 v24, v24, v24
    s_cbranch_execz L_dryret
    s_mov_b32 exec_lo, 0x30003
    s_mov_b32 exec_hi, 0x30003
    buffer_store_short v24, v3, s[16:19], 0 offen sc1
    s_or_b32 s30, s3, s88
    s_cmp_lg_u32 s30, 0
    s_cbranch_scc1 L_exit7
    s_mov_b64 exec, 1
    buffer_store_dword v9, v10, s[12:15], 0 offen sc1
L_exit7:
L_exit:
L_end:
    s_endpgm
.section .rodata,"a"
.p2align 6
.amdhsa_kernel sequential_preLN__gqa_block_cached__mixer_channel_mlp__decode_kernel
  .amdhsa_next_free_vgpr 256
  .amdhsa_next_free_sgpr 102
  .amdhsa_accum_offset 256
  .amdhsa_group_segment_fixed_size 0
  .amdhsa_kernarg_size 104
  .amdhsa_user_sgpr_count 2
  .amdhsa_user_sgpr_kernarg_segment_ptr 1
  .amdhsa_system_sgpr_workgroup_id_x 1
.end_amdhsa_kernel
```
